```python
import torch

def _softmax(x, axis=-1):
    return torch.softmax(x, dim=axis)
def _gelu(x):
    return torch.nn.functional.gelu(x, approximate="tanh")
def _silu(x):
    return torch.nn.functional.silu(x)
def _sigmoid(x):
    return torch.sigmoid(x)
def _layernorm(x, axis=-1, eps=1e-5):
    m = x.mean(dim=axis, keepdim=True)
    v = x.var(dim=axis, keepdim=True, unbiased=False)
    return (x - m) / torch.sqrt(v + eps)
def _scatter_add(tgt, idx, src, axis=0):
    return tgt.clone().index_add_(axis, idx, src)
def _segment_sum(src, seg, n):
    out = torch.zeros((n,) + src.shape[1:], dtype=src.dtype)
    return out.index_add_(0, seg, src)
def _pad(x, pw):
    flat = tuple(v for pair in reversed(pw) for v in pair)
    return torch.nn.functional.pad(x, flat)

kernel_name = 'gated_mix__mha_block__dense_activation_mish__prompt'

def setup_inputs():

    _w = (lambda a: (lambda t: t.to(torch.bfloat16) if t.is_floating_point() else t)(torch.as_tensor(a)))
    def _A_setup():
        B, S, D, H = 1, 2048, 640, 32
        return {
            "x": _w((lambda *s: torch.randn(*s, dtype=torch.bfloat16) * 0.05)(B, S, D)),
            "wqkv": _w((lambda *s: torch.randn(*s, dtype=torch.bfloat16) * 0.8)(D, 3 * D)),
            "wo": _w((lambda *s: torch.randn(*s, dtype=torch.bfloat16) * 0.05)(D, D)),
        }
    _A_in = _A_setup()

    def _B_setup():
        B, S, D, F = 1, 2048, 640, 1536
        return {
            "x": _w((lambda *s: torch.randn(*s, dtype=torch.bfloat16) * 0.05)(B, S, D)),
            "w1": _w((lambda *s: torch.randn(*s, dtype=torch.bfloat16) * 12.8)(D, F) * (D ** -0.5)),
            "b1": _w((lambda *s: torch.randn(*s, dtype=torch.bfloat16) * 0.2)(F)),
            "w2": _w((lambda *s: torch.randn(*s, dtype=torch.bfloat16) * 0.2)(F, D) * (F ** -0.5)),
        }
    _B_in = _B_setup()

    return {
        "A_x": _A_in["x"],
        "A_wqkv": _A_in["wqkv"],
        "A_wo": _A_in["wo"],
        "B_x": _B_in["x"],
        "B_w1": _B_in["w1"],
        "B_b1": _B_in["b1"],
        "B_w2": _B_in["w2"],
        "gate_w": _w((lambda *s: torch.randn(*s, dtype=torch.bfloat16) * 0.05)(640) * 16.0),
    }

def reference(A_x, A_wqkv, A_wo, B_x, B_w1, B_b1, B_w2, gate_w):
    def _A_ref(x, wqkv, wo):
        B, S, D = x.shape
        H = 32
        Dh = D // H
        qkv = (lambda x, *d: x.permute(*d))((x @ wqkv).reshape(B, S, 3, H, Dh), 2, 0, 3, 1, 4)
        q, k, v = qkv[0], qkv[1], qkv[2]
        scores = torch.einsum("bhqd,bhkd->bhqk", q, k) * (Dh ** -0.5)
        p = _softmax(scores, axis=-1)
        o = torch.einsum("bhqk,bhkd->bhqd", p, v)
        return (lambda x, *d: x.permute(*d))(o, 0, 2, 1, 3).reshape(B, S, D) @ wo

    def _B_ref(x, w1, b1, w2):
        h = torch.einsum("bsd,df->bsf", x, w1) + b1
        sp = torch.log1p(torch.exp(-torch.abs(h))) + torch.where(h > 0, h, torch.zeros_like(h))
        act = h * torch.tanh(sp)
        return torch.einsum("bsf,fd->bsd", act, w2)

    x = A_x
    g = _sigmoid((x * gate_w).sum(-1, keepdims=True))
    a = _A_ref(x, A_wqkv, A_wo)
    b = _B_ref(x, B_w1, B_b1, B_w2)
    return g * a + (1 - g) * b
```

```asm
; @launch grid=(256,1,1) block=(512,1,1) lds=163840
.amdgcn_target "amdgcn-amd-amdhsa--gfx950"
.text
.globl gated_mix__mha_block__dense_activation_mish__prompt_kernel
.p2align 8
.type gated_mix__mha_block__dense_activation_mish__prompt_kernel,@function
gated_mix__mha_block__dense_activation_mish__prompt_kernel:
    s_cmp_ge_u32 s2, 256
    s_cbranch_scc1 L_EXIT
    s_load_dwordx2 s[8:9], s[0:1], 0
    s_load_dwordx2 s[12:13], s[0:1], 8
    s_load_dwordx2 s[28:29], s[0:1], 56
    s_load_dwordx2 s[16:17], s[0:1], 32
    s_load_dwordx2 s[20:21], s[0:1], 80
    s_load_dwordx2 s[24:25], s[0:1], 40
    s_load_dwordx2 s[44:45], s[0:1], 72
    s_load_dwordx2 s[32:33], s[0:1], 48
    s_load_dwordx2 s[36:37], s[0:1], 16
    s_load_dwordx2 s[40:41], s[0:1], 64
    s_mov_b32 s10, 2621440
    s_mov_b32 s11, 0x00020000
    s_mov_b32 s14, 2457600
    s_mov_b32 s15, 0x00020000
    v_lshrrev_b32 v1, 6, v0
    v_and_b32 v0, 63, v0
    s_and_b32 s3, s2, 7
    v_readfirstlane_b32 s4, v1
    s_lshr_b32 s5, s2, 3
    s_and_b32 s7, s5, 7
    s_lshr_b32 s5, s5, 3
    s_and_b32 s6, s3, 1
    s_lshl_b32 s48, s6, 3
    s_add_u32 s48, s48, s7
    s_lshl_b32 s53, s6, 2
    s_add_u32 s53, s53, s5
    s_lshr_b32 s6, s3, 1
    s_lshl_b32 s49, s6, 2
    s_add_u32 s49, s49, s5
    s_lshl_b32 s52, s6, 3
    s_add_u32 s52, s52, s7
    s_lshl_b32 s50, s3, 2
    s_add_u32 s50, s50, s5
    s_mov_b32 s51, s7
    s_and_b32 s54, s50, 1
    s_cmp_lt_u32 s4, 4
    s_cbranch_scc1 L_MAIN
    s_sub_u32 s58, s4, 4
    v_lshrrev_b32 v2, 3, v0
    v_lshrrev_b32 v3, 4, v0
    v_xor_b32 v4, v3, v0
    v_and_b32 v4, 7, v4
    s_lshl_b32 s5, s48, 7
    s_lshl_b32 s6, s58, 5
    s_add_u32 s5, s5, s6
    v_add_u32 v2, s5, v2
    v_mul_u32_u24 v2, 1280, v2
    v_lshl_add_u32 v16, v4, 4, v2
    v_xor_b32 v17, 64, v16
    v_add_u32 v17, 9216, v17
    v_add_u32 v18, 18432, v16
    v_add_u32 v19, 18432, v17
    v_lshlrev_b32 v4, 2, v3
    v_sub_u32 v4, v0, v4
    v_and_b32 v4, 15, v4
    s_lshl_b32 s5, s58, 4
    v_add_u32 v2, s5, v3
    v_mul_u32_u24 v5, 3840, v2
    v_lshl_add_u32 v5, v4, 4, v5
    s_lshl_b32 s6, s49, 8
    v_add_u32 v20, s6, v5
    s_lshl_b32 s59, s58, 12
    s_mov_b32 s60, 245760
    s_movk_i32 s7, 14336
    s_and_b32 s5, s48, 7
    s_mul_i32 s63, s5, 10
    s_lshr_b32 s63, s63, 3
    s_cmp_eq_u32 s49, 15
    s_waitcnt lgkmcnt(0)
    s_cbranch_scc1 H_GATE
H_GATEBACK:
    v_add_u32 v21, s7, v20
    v_add_u32 v22, s7, v21
    v_add_u32 v23, s7, v22
    s_mov_b32 s61, s63
    s_add_u32 m0, s59, 0
    s_lshl_b32 s62, s61, 7
    buffer_load_dwordx4 v16, s[8:11], s62 offen offset:0 lds
    buffer_load_dwordx4 v17, s[8:11], s62 offen offset:1024 lds
    buffer_load_dwordx4 v18, s[8:11], s62 offen offset:2048 lds
    buffer_load_dwordx4 v19, s[8:11], s62 offen offset:3072 lds
    s_add_u32 m0, s59, 98304
    s_mul_i32 s62, s60, s61
    buffer_load_dwordx4 v20, s[12:15], s62 offen offset:0 lds
    buffer_load_dwordx4 v21, s[12:15], s62 offen offset:1024 lds
    buffer_load_dwordx4 v22, s[12:15], s62 offen offset:2048 lds
    buffer_load_dwordx4 v23, s[12:15], s62 offen offset:3072 lds
    s_add_u32 s61, s63, 1
    s_sub_u32 s62, s61, 10
    s_cselect_b32 s61, s61, s62
    s_add_u32 m0, s59, 16384
    s_lshl_b32 s62, s61, 7
    buffer_load_dwordx4 v16, s[8:11], s62 offen offset:0 lds
    buffer_load_dwordx4 v17, s[8:11], s62 offen offset:1024 lds
    buffer_load_dwordx4 v18, s[8:11], s62 offen offset:2048 lds
    buffer_load_dwordx4 v19, s[8:11], s62 offen offset:3072 lds
    s_add_u32 m0, s59, 114688
    s_mul_i32 s62, s60, s61
    buffer_load_dwordx4 v20, s[12:15], s62 offen offset:0 lds
    buffer_load_dwordx4 v21, s[12:15], s62 offen offset:1024 lds
    buffer_load_dwordx4 v22, s[12:15], s62 offen offset:2048 lds
    buffer_load_dwordx4 v23, s[12:15], s62 offen offset:3072 lds
    s_mov_b32 s18, 1966080
    s_mov_b32 s19, 0x00020000
    s_mov_b32 s22, 22020096
    s_mov_b32 s23, 0x00020000
    s_mov_b32 s26, 3072
    s_mov_b32 s27, 0x00020000
    s_mov_b32 s46, 256
    s_mov_b32 s47, 0x00020000
    s_mov_b32 s34, 1966080
    s_mov_b32 s35, 0x00020000
    s_mov_b32 s38, 819200
    s_mov_b32 s39, 0x00020000
    s_mov_b32 s42, 2621440
    s_mov_b32 s43, 0x00020000
    s_movk_i32 s7, 3072
    s_mul_i32 s6, s49, 192
    s_mul_i32 s5, s58, 49152
    s_add_u32 s6, s6, s5
    s_mov_b32 s5, 43691
    v_add_u32 v2, 0, v0
    v_mul_lo_u32 v3, v2, s5
    v_lshrrev_b32 v3, 19, v3
    v_mul_u32_u24 v4, 12, v3
    v_sub_u32 v4, v2, v4
    v_mul_lo_u32 v5, v3, s7
    v_lshl_add_u32 v5, v4, 4, v5
    v_add_u32 v24, s6, v5
    s_sub_u32 s6, s6, 1024
    v_add_u32 v2, 64, v0
    v_mul_lo_u32 v3, v2, s5
    v_lshrrev_b32 v3, 19, v3
    v_mul_u32_u24 v4, 12, v3
    v_sub_u32 v4, v2, v4
    v_mul_lo_u32 v5, v3, s7
    v_lshl_add_u32 v5, v4, 4, v5
    v_add_u32 v25, s6, v5
    s_sub_u32 s6, s6, 1024
    v_add_u32 v2, 128, v0
    v_mul_lo_u32 v3, v2, s5
    v_lshrrev_b32 v3, 19, v3
    v_mul_u32_u24 v4, 12, v3
    v_sub_u32 v4, v2, v4
    v_mul_lo_u32 v5, v3, s7
    v_lshl_add_u32 v5, v4, 4, v5
    v_add_u32 v26, s6, v5
    s_sub_u32 s6, s6, 1024
    v_lshlrev_b32 v31, 2, v0
    v_add_u32 v31, 155648, v31
    v_lshlrev_b32 v30, 1, v0
    s_mul_i32 s3, s58, 3072
    s_waitcnt vmcnt(8)
    s_barrier
    s_add_u32 s61, s63, 2
    s_sub_u32 s62, s61, 10
    s_cselect_b32 s61, s61, s62
    s_add_u32 m0, s59, 49152
    s_lshl_b32 s62, s61, 7
    buffer_load_dwordx4 v16, s[8:11], s62 offen offset:0 lds
    buffer_load_dwordx4 v17, s[8:11], s62 offen offset:1024 lds
    buffer_load_dwordx4 v18, s[8:11], s62 offen offset:2048 lds
    buffer_load_dwordx4 v19, s[8:11], s62 offen offset:3072 lds
    s_add_u32 m0, s59, 65536
    s_mul_i32 s62, s60, s61
    buffer_load_dwordx4 v20, s[12:15], s62 offen offset:0 lds
    buffer_load_dwordx4 v21, s[12:15], s62 offen offset:1024 lds
    buffer_load_dwordx4 v22, s[12:15], s62 offen offset:2048 lds
    buffer_load_dwordx4 v23, s[12:15], s62 offen offset:3072 lds
    s_add_u32 s61, s63, 3
    s_sub_u32 s62, s61, 10
    s_cselect_b32 s61, s61, s62
    s_add_u32 m0, s59, 32768
    s_lshl_b32 s62, s61, 7
    buffer_load_dwordx4 v16, s[8:11], s62 offen offset:0 lds
    buffer_load_dwordx4 v17, s[8:11], s62 offen offset:1024 lds
    buffer_load_dwordx4 v18, s[8:11], s62 offen offset:2048 lds
    buffer_load_dwordx4 v19, s[8:11], s62 offen offset:3072 lds
    s_add_u32 m0, s59, 81920
    s_mul_i32 s62, s60, s61
    buffer_load_dwordx4 v20, s[12:15], s62 offen offset:0 lds
    buffer_load_dwordx4 v21, s[12:15], s62 offen offset:1024 lds
    buffer_load_dwordx4 v22, s[12:15], s62 offen offset:2048 lds
    buffer_load_dwordx4 v23, s[12:15], s62 offen offset:3072 lds
    s_waitcnt vmcnt(16)
    s_barrier
    s_mul_i32 s5, s58, 5120
    v_add_u32 v3, 0, v0
    v_cmp_le_u32 vcc, 96, v3
    v_lshlrev_b32 v3, 4, v3
    v_add_u32 v4, 1024, v3
    v_cndmask_b32 v3, v3, v4, vcc
    v_add_u32 v240, s5, v3
    s_sub_u32 s5, s5, 1024
    v_add_u32 v3, 64, v0
    v_cmp_le_u32 vcc, 96, v3
    v_lshlrev_b32 v3, 4, v3
    v_add_u32 v4, 1024, v3
    v_cndmask_b32 v3, v3, v4, vcc
    v_add_u32 v241, s5, v3
    s_sub_u32 s5, s5, 1024
    v_add_u32 v3, 128, v0
    v_cmp_le_u32 vcc, 96, v3
    v_lshlrev_b32 v3, 4, v3
    v_add_u32 v4, 1024, v3
    v_cndmask_b32 v3, v3, v4, vcc
    v_add_u32 v242, s5, v3
    s_sub_u32 s5, s5, 1024
    s_mul_i32 s5, s58, 2560
    s_add_u32 s5, s5, 2048
    s_movk_i32 s6, 2979
    v_add_u32 v3, 0, v0
    v_mul_u32_u24 v4, s6, v3
    v_lshrrev_b32 v4, 16, v4
    v_lshlrev_b32 v4, 1, v4
    v_sub_u32 v3, v3, v4
    v_lshlrev_b32 v3, 4, v3
    v_add_u32 v243, s5, v3
    s_sub_u32 s5, s5, 1024
    v_add_u32 v3, 64, v0
    v_mul_u32_u24 v4, s6, v3
    v_lshrrev_b32 v4, 16, v4
    v_lshlrev_b32 v4, 1, v4
    v_sub_u32 v3, v3, v4
    v_lshlrev_b32 v3, 4, v3
    v_add_u32 v244, s5, v3
    s_sub_u32 s5, s5, 1024
    v_add_u32 v3, 128, v0
    v_mul_u32_u24 v4, s6, v3
    v_lshrrev_b32 v4, 16, v4
    v_lshlrev_b32 v4, 1, v4
    v_sub_u32 v3, v3, v4
    v_lshlrev_b32 v3, 4, v3
    v_add_u32 v245, s5, v3
    s_sub_u32 s5, s5, 1024
    s_lshr_b32 s5, s50, 1
    s_mul_i32 s5, s5, 5
    s_lshl_b32 s6, s54, 1
    s_add_u32 s5, s5, s6
    s_add_u32 s6, s5, 2
    s_lshr_b32 s5, s5, 4
    s_lshr_b32 s6, s6, 4
    s_mul_i32 s7, s50, 20
    s_add_u32 s62, s7, 19
    s_lshr_b32 s7, s7, 7
    s_lshr_b32 s62, s62, 7
    s_lshl_b32 s56, s6, 8
    s_or_b32 s56, s56, s5
    s_or_b32 s57, s56, 0x0f0f0000
    s_lshl_b32 s7, s7, 16
    s_lshl_b32 s62, s62, 24
    s_or_b32 s56, s56, s7
    s_or_b32 s56, s56, s62
    s_add_u32 s56, s56, 0x0a0a0505
    s_lshr_b32 s5, s58, 1
    s_and_b32 s6, s58, 1
    s_lshl_b32 s6, s6, 3
    v_and_b32 v3, 3, v0
    v_lshlrev_b32 v3, 3, v3
    v_lshrrev_b32 v4, v3, s56
    v_and_b32 v4, 15, v4
    v_lshrrev_b32 v5, v3, s57
    v_and_b32 v5, 15, v5
    v_bfe_u32 v6, v0, 2, 3
    v_lshl_add_u32 v7, v6, 1, s5
    v_lshl_add_u32 v7, v4, 4, v7
    v_lshl_add_u32 v255, v7, 7, s6
    v_and_b32 v6, 1, v6
    v_lshl_add_u32 v7, v6, 1, s5
    v_lshl_add_u32 v7, v4, 4, v7
    s_lshl_b32 s7, s51, 1
    s_add_u32 s5, s5, s7
    v_lshl_add_u32 v5, v5, 4, s5
    v_cmp_gt_u32 vcc, 32, v0
    s_nop 1
    v_cndmask_b32 v7, v5, v7, vcc
    v_lshl_add_u32 v254, v7, 7, s6
    v_lshrrev_b32 v2, 3, v0
    v_cmp_eq_u32 vcc, 1, v2
    v_mov_b32 v3, 131072
    v_mov_b32 v4, 57344
    v_cndmask_b32 v3, v3, v4, vcc
    v_cmp_eq_u32 vcc, 2, v2
    v_mov_b32 v4, 32768
    v_and_b32 v5, 7, v0
    v_cndmask_b32 v3, v3, v4, vcc
    v_mul_u32_u24 v5, 352, v5
    s_mul_i32 s5, s58, 2816
    s_add_u32 s5, s5, 12608
    v_add3_u32 v15, v3, v5, s5
    v_mov_b32 v120, 0x3f803f80
    v_mov_b32 v121, v120
    v_mov_b32 v122, v120
    v_mov_b32 v123, v120
    s_waitcnt vmcnt(8)
    s_barrier
    s_add_u32 s61, s63, 4
    s_sub_u32 s62, s61, 10
    s_cselect_b32 s61, s61, s62
    s_add_u32 m0, s59, 0
    s_lshl_b32 s62, s61, 7
    buffer_load_dwordx4 v16, s[8:11], s62 offen offset:0 lds
    buffer_load_dwordx4 v17, s[8:11], s62 offen offset:1024 lds
    buffer_load_dwordx4 v18, s[8:11], s62 offen offset:2048 lds
    buffer_load_dwordx4 v19, s[8:11], s62 offen offset:3072 lds
    s_add_u32 m0, s59, 98304
    s_mul_i32 s62, s60, s61
    buffer_load_dwordx4 v20, s[12:15], s62 offen offset:0 lds
    buffer_load_dwordx4 v21, s[12:15], s62 offen offset:1024 lds
    buffer_load_dwordx4 v22, s[12:15], s62 offen offset:2048 lds
    buffer_load_dwordx4 v23, s[12:15], s62 offen offset:3072 lds
    s_waitcnt vmcnt(8)
    s_barrier
    s_mul_i32 s5, s49, 192
    buffer_load_dword v27, off, s[44:47], 0 sc1
    buffer_load_ushort v28, v30, s[24:27], s5 offen
    buffer_load_ushort v29, v30, s[24:27], s5 offen offset:128
    s_add_u32 s61, s63, 5
    s_sub_u32 s62, s61, 10
    s_cselect_b32 s61, s61, s62
    s_add_u32 m0, s59, 16384
    s_lshl_b32 s62, s61, 7
    buffer_load_dwordx4 v16, s[8:11], s62 offen offset:0 lds
    buffer_load_dwordx4 v17, s[8:11], s62 offen offset:1024 lds
    buffer_load_dwordx4 v18, s[8:11], s62 offen offset:2048 lds
    buffer_load_dwordx4 v19, s[8:11], s62 offen offset:3072 lds
    s_add_u32 m0, s59, 114688
    s_mul_i32 s62, s60, s61
    buffer_load_dwordx4 v20, s[12:15], s62 offen offset:0 lds
    buffer_load_dwordx4 v21, s[12:15], s62 offen offset:1024 lds
    buffer_load_dwordx4 v22, s[12:15], s62 offen offset:2048 lds
    buffer_load_dwordx4 v23, s[12:15], s62 offen offset:3072 lds
    s_waitcnt vmcnt(11)
    s_barrier
    s_add_u32 s61, s63, 6
    s_sub_u32 s62, s61, 10
    s_cselect_b32 s61, s61, s62
    s_add_u32 m0, s59, 49152
    s_lshl_b32 s62, s61, 7
    buffer_load_dwordx4 v16, s[8:11], s62 offen offset:0 lds
    buffer_load_dwordx4 v17, s[8:11], s62 offen offset:1024 lds
    buffer_load_dwordx4 v18, s[8:11], s62 offen offset:2048 lds
    buffer_load_dwordx4 v19, s[8:11], s62 offen offset:3072 lds
    s_add_u32 m0, s59, 65536
    s_mul_i32 s62, s60, s61
    buffer_load_dwordx4 v20, s[12:15], s62 offen offset:0 lds
    buffer_load_dwordx4 v21, s[12:15], s62 offen offset:1024 lds
    buffer_load_dwordx4 v22, s[12:15], s62 offen offset:2048 lds
    buffer_load_dwordx4 v23, s[12:15], s62 offen offset:3072 lds
    s_and_b32 s30, s53, 1
    s_lshr_b32 s6, s53, 1
    s_mul_i32 s6, s6, 320
    s_lshl_b32 s5, s30, 7
    s_add_u32 s6, s6, s5
    s_mov_b32 s5, 43691
    s_movk_i32 s7, 1280
    v_add_u32 v2, 0, v0
    v_mul_lo_u32 v3, v2, s5
    v_lshrrev_b32 v3, 19, v3
    v_mul_u32_u24 v4, 12, v3
    v_sub_u32 v4, v2, v4
    v_lshlrev_b32 v4, 4, v4
    v_add_u32 v4, s6, v4
    v_mad_u32_u24 v246, v3, s7, v4
    v_bfe_u32 v5, v3, 2, 1
    v_mul_u32_u24 v5, 40, v5
    v_lshrrev_b32 v6, 3, v3
    v_mul_u32_u24 v6, 20, v6
    v_and_b32 v3, 3, v3
    v_add3_u32 v5, v5, v6, v3
    v_add_u32 v5, 16, v5
    v_mad_u32_u24 v249, v5, s7, v4
    s_sub_u32 s6, s6, 1024
    v_add_u32 v2, 64, v0
    v_mul_lo_u32 v3, v2, s5
    v_lshrrev_b32 v3, 19, v3
    v_mul_u32_u24 v4, 12, v3
    v_sub_u32 v4, v2, v4
    v_lshlrev_b32 v4, 4, v4
    v_add_u32 v4, s6, v4
    v_mad_u32_u24 v247, v3, s7, v4
    v_bfe_u32 v5, v3, 2, 1
    v_mul_u32_u24 v5, 40, v5
    v_lshrrev_b32 v6, 3, v3
    v_mul_u32_u24 v6, 20, v6
    v_and_b32 v3, 3, v3
    v_add3_u32 v5, v5, v6, v3
    v_add_u32 v5, 16, v5
    v_mad_u32_u24 v250, v5, s7, v4
    s_sub_u32 s6, s6, 1024
    v_add_u32 v2, 128, v0
    v_mul_lo_u32 v3, v2, s5
    v_lshrrev_b32 v3, 19, v3
    v_mul_u32_u24 v4, 12, v3
    v_sub_u32 v4, v2, v4
    v_lshlrev_b32 v4, 4, v4
    v_add_u32 v4, s6, v4
    v_mad_u32_u24 v248, v3, s7, v4
    v_bfe_u32 v5, v3, 2, 1
    v_mul_u32_u24 v5, 40, v5
    v_lshrrev_b32 v6, 3, v3
    v_mul_u32_u24 v6, 20, v6
    v_and_b32 v3, 3, v3
    v_add3_u32 v5, v5, v6, v3
    v_add_u32 v5, 16, v5
    v_mad_u32_u24 v251, v5, s7, v4
    s_sub_u32 s6, s6, 1024
    v_lshlrev_b32 v252, 4, v0
    v_lshrrev_b32 v2, 5, v0
    v_and_b32 v3, 31, v0
    v_lshlrev_b32 v3, 3, v3
    v_lshl_add_u32 v253, v2, 9, v3
    v_bfe_u32 v3, v0, 4, 1
    v_bfe_u32 v4, v0, 2, 2
    v_and_b32 v5, 3, v0
    v_lshl_add_u32 v4, v2, 2, v4
    v_mul_u32_u24 v4, 192, v4
    v_lshl_add_u32 v4, v3, 5, v4
    v_lshl_add_u32 v4, v5, 3, v4
    s_lshl_b32 s5, s30, 6
    s_add_u32 s5, s5, s3
    v_add_u32 v32, s5, v4
    v_add_u32 v33, 0x10000, v32
    v_add_u32 v34, 0x20000, v32
    s_xor_b32 s5, s30, 1
    s_lshl_b32 s5, s5, 7
    s_add_u32 s5, s5, s3
    v_add_u32 v12, s5, v4
    v_add_u32 v13, 0x10000, v12
    v_add_u32 v14, 0x20000, v12
    s_lshr_b32 s5, s52, 1
    s_lshl_b32 s6, s5, 4
    s_lshl_b32 s7, s58, 2
    s_add_u32 s6, s6, s7
    s_add_u32 s6, s6, 256
    v_and_b32 v2, 3, v0
    v_add_u32 v2, s6, v2
    s_add_u32 s5, s5, 240
    v_mov_b32 v3, s5
    v_cmp_gt_u32 vcc, 32, v0
    s_and_b32 s6, s52, 1
    s_lshl_b32 s6, s6, 3
    v_cndmask_b32 v2, v3, v2, vcc
    v_lshl_add_u32 v35, v2, 7, s6
    s_waitcnt vmcnt(8)
    s_barrier
    s_add_u32 s61, s63, 7
    s_sub_u32 s62, s61, 10
    s_cselect_b32 s61, s61, s62
    s_add_u32 m0, s59, 32768
    s_lshl_b32 s62, s61, 7
    buffer_load_dwordx4 v16, s[8:11], s62 offen offset:0 lds
    buffer_load_dwordx4 v17, s[8:11], s62 offen offset:1024 lds
    buffer_load_dwordx4 v18, s[8:11], s62 offen offset:2048 lds
    buffer_load_dwordx4 v19, s[8:11], s62 offen offset:3072 lds
    s_add_u32 m0, s59, 81920
    s_mul_i32 s62, s60, s61
    buffer_load_dwordx4 v20, s[12:15], s62 offen offset:0 lds
    buffer_load_dwordx4 v21, s[12:15], s62 offen offset:1024 lds
    buffer_load_dwordx4 v22, s[12:15], s62 offen offset:2048 lds
    buffer_load_dwordx4 v23, s[12:15], s62 offen offset:3072 lds
    v_mov_b32 v40, 0
    v_mov_b32 v41, 0
    v_mov_b32 v42, 0
    v_mov_b32 v43, 0
    v_mov_b32 v44, 0
    v_mov_b32 v45, 0
    v_mov_b32 v46, 0
    v_mov_b32 v47, 0
    v_mov_b32 v48, 0
    v_mov_b32 v49, 0
    v_mov_b32 v50, 0
    v_mov_b32 v51, 0
    v_mov_b32 v52, 0
    v_mov_b32 v53, 0
    v_mov_b32 v54, 0
    v_mov_b32 v55, 0
    v_mov_b32 v56, 0
    v_mov_b32 v57, 0
    v_mov_b32 v58, 0
    v_mov_b32 v59, 0
    v_mov_b32 v60, 0
    v_mov_b32 v61, 0
    v_mov_b32 v62, 0
    v_mov_b32 v63, 0
    v_mov_b32 v64, 0
    v_mov_b32 v65, 0
    v_mov_b32 v66, 0
    v_mov_b32 v67, 0
    v_mov_b32 v68, 0
    v_mov_b32 v69, 0
    v_mov_b32 v70, 0
    v_mov_b32 v71, 0
    v_mov_b32 v72, 0
    v_mov_b32 v73, 0
    v_mov_b32 v74, 0
    v_mov_b32 v75, 0
    v_mov_b32 v76, 0
    v_mov_b32 v77, 0
    v_mov_b32 v78, 0
    v_mov_b32 v79, 0
    v_mov_b32 v80, 0
    v_mov_b32 v81, 0
    v_mov_b32 v82, 0
    v_mov_b32 v83, 0
    v_mov_b32 v84, 0
    v_mov_b32 v85, 0
    v_mov_b32 v86, 0
    v_mov_b32 v87, 0
    v_mov_b32 v88, 0
    v_mov_b32 v89, 0
    v_mov_b32 v90, 0
    v_mov_b32 v91, 0
    v_mov_b32 v92, 0
    v_mov_b32 v93, 0
    v_mov_b32 v94, 0
    v_mov_b32 v95, 0
    v_mov_b32 v96, 0
    v_mov_b32 v97, 0
    v_mov_b32 v98, 0
    v_mov_b32 v99, 0
    v_mov_b32 v100, 0
    v_mov_b32 v101, 0
    v_mov_b32 v102, 0
    v_mov_b32 v103, 0
    v_mov_b32 v104, 0
    v_mov_b32 v105, 0
    v_mov_b32 v106, 0
    v_mov_b32 v107, 0
    v_mov_b32 v108, 0
    v_mov_b32 v109, 0
    v_mov_b32 v110, 0
    v_mov_b32 v111, 0
    v_mov_b32 v112, 0
    v_mov_b32 v113, 0
    v_mov_b32 v114, 0
    v_mov_b32 v115, 0
    v_mov_b32 v116, 0
    v_mov_b32 v117, 0
    v_mov_b32 v118, 0
    v_mov_b32 v119, 0
    s_lshl_b32 s5, s52, 1
    s_add_u32 s5, s5, s30
    s_xor_b32 s6, s5, 1
    s_mul_i32 s7, s58, 24576
    s_add_u32 s7, s7, 10485760
    s_mul_i32 s24, s5, 98304
    s_add_u32 s24, s24, s7
    s_mul_i32 s25, s6, 98304
    s_add_u32 s25, s25, s7
    s_mul_i32 s28, s5, 40960
    s_add_u32 s28, s28, 17825792
    s_mul_i32 s29, s6, 40960
    s_add_u32 s29, s29, 17825792
    s_mul_i32 s26, s58, 491520
    s_mul_i32 s27, s58, 204800
    s_lshl_b32 s5, s5, 7
    s_add_u32 s31, s5, 20971520
    s_waitcnt vmcnt(8)
    s_barrier
    s_add_u32 s61, s63, 8
    s_sub_u32 s62, s61, 10
    s_cselect_b32 s61, s61, s62
    s_add_u32 m0, s59, 0
    s_lshl_b32 s62, s61, 7
    buffer_load_dwordx4 v16, s[8:11], s62 offen offset:0 lds
    buffer_load_dwordx4 v17, s[8:11], s62 offen offset:1024 lds
    buffer_load_dwordx4 v18, s[8:11], s62 offen offset:2048 lds
    buffer_load_dwordx4 v19, s[8:11], s62 offen offset:3072 lds
    s_add_u32 m0, s59, 98304
    s_mul_i32 s62, s60, s61
    buffer_load_dwordx4 v20, s[12:15], s62 offen offset:0 lds
    buffer_load_dwordx4 v21, s[12:15], s62 offen offset:1024 lds
    buffer_load_dwordx4 v22, s[12:15], s62 offen offset:2048 lds
    buffer_load_dwordx4 v23, s[12:15], s62 offen offset:3072 lds
    v_lshlrev_b32 v28, 16, v28
    v_lshlrev_b32 v29, 16, v29
    ds_write_b32 v31, v28
    ds_write_b32 v31, v29 offset:256
    s_waitcnt vmcnt(8)
    s_barrier
    s_add_u32 s61, s63, 9
    s_sub_u32 s62, s61, 10
    s_cselect_b32 s61, s61, s62
    s_add_u32 m0, s59, 16384
    s_lshl_b32 s62, s61, 7
    buffer_load_dwordx4 v16, s[8:11], s62 offen offset:0 lds
    buffer_load_dwordx4 v17, s[8:11], s62 offen offset:1024 lds
    buffer_load_dwordx4 v18, s[8:11], s62 offen offset:2048 lds
    buffer_load_dwordx4 v19, s[8:11], s62 offen offset:3072 lds
    s_add_u32 m0, s59, 114688
    s_mul_i32 s62, s60, s61
    buffer_load_dwordx4 v20, s[12:15], s62 offen offset:0 lds
    buffer_load_dwordx4 v21, s[12:15], s62 offen offset:1024 lds
    buffer_load_dwordx4 v22, s[12:15], s62 offen offset:2048 lds
    buffer_load_dwordx4 v23, s[12:15], s62 offen offset:3072 lds
    s_mov_b32 s61, s63
    s_add_u32 m0, s3, 131072
    s_mul_i32 s62, s61, 196608
    buffer_load_dwordx4 v24, s[16:19], s62 offen offset:0 lds
    buffer_load_dwordx4 v25, s[16:19], s62 offen offset:1024 lds
    buffer_load_dwordx4 v26, s[16:19], s62 offen offset:2048 lds
    s_add_u32 s61, s63, 1
    s_sub_u32 s62, s61, 10
    s_cselect_b32 s61, s61, s62
    s_add_u32 m0, s3, 143360
    s_mul_i32 s62, s61, 196608
    buffer_load_dwordx4 v24, s[16:19], s62 offen offset:0 lds
    buffer_load_dwordx4 v25, s[16:19], s62 offen offset:1024 lds
    buffer_load_dwordx4 v26, s[16:19], s62 offen offset:2048 lds
    s_waitcnt vmcnt(14)
    s_barrier
    s_add_u32 s61, s63, 2
    s_sub_u32 s62, s61, 10
    s_cselect_b32 s61, s61, s62
    s_add_u32 m0, s3, 57344
    s_mul_i32 s62, s61, 196608
    buffer_load_dwordx4 v24, s[16:19], s62 offen offset:0 lds
    buffer_load_dwordx4 v25, s[16:19], s62 offen offset:1024 lds
    buffer_load_dwordx4 v26, s[16:19], s62 offen offset:2048 lds
    s_add_u32 s61, s63, 3
    s_sub_u32 s62, s61, 10
    s_cselect_b32 s61, s61, s62
    s_add_u32 m0, s3, 69632
    s_mul_i32 s62, s61, 196608
    buffer_load_dwordx4 v24, s[16:19], s62 offen offset:0 lds
    buffer_load_dwordx4 v25, s[16:19], s62 offen offset:1024 lds
    buffer_load_dwordx4 v26, s[16:19], s62 offen offset:2048 lds
    s_waitcnt vmcnt(12)
    s_barrier
    s_add_u32 s61, s63, 4
    s_sub_u32 s62, s61, 10
    s_cselect_b32 s61, s61, s62
    s_add_u32 m0, s3, 32768
    s_mul_i32 s62, s61, 196608
    buffer_load_dwordx4 v24, s[16:19], s62 offen offset:0 lds
    buffer_load_dwordx4 v25, s[16:19], s62 offen offset:1024 lds
    buffer_load_dwordx4 v26, s[16:19], s62 offen offset:2048 lds
    s_add_u32 s61, s63, 5
    s_sub_u32 s62, s61, 10
    s_cselect_b32 s61, s61, s62
    s_add_u32 m0, s3, 45056
    s_mul_i32 s62, s61, 196608
    buffer_load_dwordx4 v24, s[16:19], s62 offen offset:0 lds
    buffer_load_dwordx4 v25, s[16:19], s62 offen offset:1024 lds
    buffer_load_dwordx4 v26, s[16:19], s62 offen offset:2048 lds
    v_readfirstlane_b32 s55, v27
    s_mov_b32 s7, 400000
H_NONCE:
    s_cmp_lg_u32 s55, 0
    s_cbranch_scc1 H_NONCE_OK
    buffer_load_dword v27, off, s[44:47], 0 sc1
    s_sub_u32 s7, s7, 1
    s_waitcnt vmcnt(0)
    v_readfirstlane_b32 s55, v27
    s_cmp_lg_u32 s7, 0
    s_cbranch_scc1 H_NONCE
H_NONCE_OK:
    v_mov_b32 v2, 156160
    v_mov_b32 v3, s55
    ds_write_b32 v2, v3
    s_waitcnt vmcnt(6) lgkmcnt(0)
    s_barrier
    s_add_u32 s61, s63, 6
    s_sub_u32 s62, s61, 10
    s_cselect_b32 s61, s61, s62
    s_add_u32 m0, s3, 81920
    s_mul_i32 s62, s61, 196608
    buffer_load_dwordx4 v24, s[16:19], s62 offen offset:0 lds
    buffer_load_dwordx4 v25, s[16:19], s62 offen offset:1024 lds
    buffer_load_dwordx4 v26, s[16:19], s62 offen offset:2048 lds
    s_add_u32 s61, s63, 7
    s_sub_u32 s62, s61, 10
    s_cselect_b32 s61, s61, s62
    s_add_u32 m0, s3, 94208
    s_mul_i32 s62, s61, 196608
    buffer_load_dwordx4 v24, s[16:19], s62 offen offset:0 lds
    buffer_load_dwordx4 v25, s[16:19], s62 offen offset:1024 lds
    buffer_load_dwordx4 v26, s[16:19], s62 offen offset:2048 lds
    s_add_u32 s61, s63, 8
    s_sub_u32 s62, s61, 10
    s_cselect_b32 s61, s61, s62
    s_add_u32 m0, s3, 106496
    s_mul_i32 s62, s61, 196608
    buffer_load_dwordx4 v24, s[16:19], s62 offen offset:0 lds
    buffer_load_dwordx4 v25, s[16:19], s62 offen offset:1024 lds
    buffer_load_dwordx4 v26, s[16:19], s62 offen offset:2048 lds
    s_add_u32 s61, s63, 9
    s_sub_u32 s62, s61, 10
    s_cselect_b32 s61, s61, s62
    s_add_u32 m0, s3, 118784
    s_mul_i32 s62, s61, 196608
    buffer_load_dwordx4 v24, s[16:19], s62 offen offset:0 lds
    buffer_load_dwordx4 v25, s[16:19], s62 offen offset:1024 lds
    buffer_load_dwordx4 v26, s[16:19], s62 offen offset:2048 lds
    s_lshr_b32 s5, s50, 1
    s_mul_i32 s5, s5, 163840
    s_lshl_b32 s6, s54, 10
    s_add_u32 s60, s5, s6
    s_add_u32 s61, s60, 2621440
    s_mul_i32 s5, s51, 20480
    s_add_u32 s60, s60, s5
    s_mul_i32 s63, s50, 81920
    s_add_u32 s63, s63, 6289408
    s_mul_i32 s59, s58, 2816
    s_add_u32 s59, s59, 12288
    s_waitcnt vmcnt(9)
    s_barrier
    s_waitcnt vmcnt(0)
    s_barrier
    s_mov_b64 exec, 0xffffff
    ds_write_b128 v15, v[120:123]
    ds_write_b128 v15, v[40:43] offset:16
    s_mov_b64 exec, -1
    s_mov_b32 s5, 21037056
    s_mov_b32 s7, 400000
H_POLLA:
    buffer_load_dwordx2 v[4:5], v254, s[20:23], s5 offen sc1
    s_waitcnt vmcnt(0)
    s_setprio 2
    v_xor_b32 v4, s55, v4
    v_xor_b32 v5, s55, v5
    v_or3_b32 v4, v4, v5, v5
    v_cmp_ne_u32 vcc, 0, v4
    s_setprio 0
    s_cmp_eq_u64 vcc, 0
    s_cbranch_scc1 H_POLLA_OK
    s_sub_u32 s7, s7, 1
    s_cmp_eq_u32 s7, 0
    s_cbranch_scc1 H_POLLA_OK
    s_sleep 2
    s_branch H_POLLA
H_POLLA_OK:
    s_add_u32 m0, s3, 32768
    s_nop 0
    buffer_load_dwordx4 v240, s[20:23], s60 offen offset:0 sc1 lds
    buffer_load_dwordx4 v241, s[20:23], s60 offen offset:1024 sc1 lds
    buffer_load_dwordx4 v242, s[20:23], s60 offen offset:2048 sc1 lds
    s_lshl_b32 s5, s58, 8
    s_add_u32 m0, s5, 156672
    s_lshl_b32 s6, s51, 10
    s_add_u32 s5, s5, s6
    s_add_u32 s5, s5, 20971520
    v_lshlrev_b32 v2, 2, v0
    buffer_load_dword v2, s[20:23], s5 offen sc1 lds
    s_add_u32 m0, s3, 131072
    s_add_u32 s62, s61, 0
    buffer_load_dwordx4 v240, s[20:23], s62 offen offset:0 sc1 lds
    buffer_load_dwordx4 v241, s[20:23], s62 offen offset:1024 sc1 lds
    buffer_load_dwordx4 v242, s[20:23], s62 offen offset:2048 sc1 lds
    s_add_u32 m0, s59, 131072
    s_add_u32 s62, s63, 0
    s_mov_b32 exec_lo, 0xffcfffff
    s_mov_b32 exec_hi, 0xfffff3ff
    buffer_load_dwordx4 v243, s[20:23], s62 offen offset:0 sc1 lds
    s_mov_b32 exec_lo, 0xff3ffffc
    s_mov_b32 exec_hi, 0xffffcfff
    buffer_load_dwordx4 v244, s[20:23], s62 offen offset:1024 sc1 lds
    s_mov_b32 exec_lo, 0xfcfffff3
    s_mov_b32 exec_hi, 0x3fff
    buffer_load_dwordx4 v245, s[20:23], s62 offen offset:2048 sc1 lds
    s_mov_b64 exec, -1
    s_waitcnt vmcnt(0) lgkmcnt(0)
    s_barrier
    s_mov_b32 s5, 21037056
    buffer_load_dwordx2 v[6:7], v255, s[20:23], s5 offen sc1
    s_add_u32 m0, s3, 57344
    s_add_u32 s62, s61, 20480
    buffer_load_dwordx4 v240, s[20:23], s62 offen offset:0 sc1 lds
    buffer_load_dwordx4 v241, s[20:23], s62 offen offset:1024 sc1 lds
    buffer_load_dwordx4 v242, s[20:23], s62 offen offset:2048 sc1 lds
    s_add_u32 m0, s59, 57344
    s_add_u32 s62, s63, 10240
    s_mov_b32 exec_lo, 0xffcfffff
    s_mov_b32 exec_hi, 0xfffff3ff
    buffer_load_dwordx4 v243, s[20:23], s62 offen offset:0 sc1 lds
    s_mov_b32 exec_lo, 0xff3ffffc
    s_mov_b32 exec_hi, 0xffffcfff
    buffer_load_dwordx4 v244, s[20:23], s62 offen offset:1024 sc1 lds
    s_mov_b32 exec_lo, 0xfcfffff3
    s_mov_b32 exec_hi, 0x3fff
    buffer_load_dwordx4 v245, s[20:23], s62 offen offset:2048 sc1 lds
    s_mov_b64 exec, -1
    s_and_b32 s44, s52, 7
    s_mul_i32 s44, s44, 3
    s_add_u32 s6, s44, 0
    s_sub_u32 s7, s6, 24
    s_cselect_b32 s6, s6, s7
    s_mul_i32 s62, s6, 20480
    s_add_u32 m0, s3, 81920
    s_add_u32 s62, s62, s26
    buffer_load_dwordx4 v246, s[32:35], s62 offen offset:0 lds
    buffer_load_dwordx4 v247, s[32:35], s62 offen offset:1024 lds
    buffer_load_dwordx4 v248, s[32:35], s62 offen offset:2048 lds
    s_add_u32 s6, s44, 1
    s_sub_u32 s7, s6, 24
    s_cselect_b32 s6, s6, s7
    s_mul_i32 s62, s6, 20480
    s_add_u32 m0, s3, 94208
    s_add_u32 s62, s62, s26
    buffer_load_dwordx4 v246, s[32:35], s62 offen offset:0 lds
    buffer_load_dwordx4 v247, s[32:35], s62 offen offset:1024 lds
    buffer_load_dwordx4 v248, s[32:35], s62 offen offset:2048 lds
    s_add_u32 s6, s44, 2
    s_sub_u32 s7, s6, 24
    s_cselect_b32 s6, s6, s7
    s_mul_i32 s62, s6, 20480
    s_add_u32 m0, s3, 106496
    s_add_u32 s62, s62, s26
    buffer_load_dwordx4 v246, s[32:35], s62 offen offset:0 lds
    buffer_load_dwordx4 v247, s[32:35], s62 offen offset:1024 lds
    buffer_load_dwordx4 v248, s[32:35], s62 offen offset:2048 lds
    s_waitcnt vmcnt(9)
    s_barrier
    s_setprio 2
    v_xor_b32 v6, s55, v6
    v_xor_b32 v7, s55, v7
    v_or_b32 v6, v6, v7
    v_cmp_ne_u32 vcc, 0, v6
    s_setprio 0
    s_cmp_lg_u64 vcc, 0
    s_cbranch_scc1 H_POLLA2_SLOW
H_POLLA2_BACK:
    s_add_u32 m0, s3, 32768
    s_add_u32 s62, s61, 40960
    buffer_load_dwordx4 v240, s[20:23], s62 offen offset:0 sc1 lds
    buffer_load_dwordx4 v241, s[20:23], s62 offen offset:1024 sc1 lds
    buffer_load_dwordx4 v242, s[20:23], s62 offen offset:2048 sc1 lds
    s_add_u32 m0, s59, 32768
    s_add_u32 s62, s63, 20480
    s_mov_b32 exec_lo, 0xffcfffff
    s_mov_b32 exec_hi, 0xfffff3ff
    buffer_load_dwordx4 v243, s[20:23], s62 offen offset:0 sc1 lds
    s_mov_b32 exec_lo, 0xff3ffffc
    s_mov_b32 exec_hi, 0xffffcfff
    buffer_load_dwordx4 v244, s[20:23], s62 offen offset:1024 sc1 lds
    s_mov_b32 exec_lo, 0xfcfffff3
    s_mov_b32 exec_hi, 0x3fff
    buffer_load_dwordx4 v245, s[20:23], s62 offen offset:2048 sc1 lds
    s_mov_b64 exec, -1
    s_add_u32 s6, s44, 3
    s_sub_u32 s7, s6, 24
    s_cselect_b32 s6, s6, s7
    s_mul_i32 s62, s6, 20480
    s_add_u32 m0, s3, 118784
    s_add_u32 s62, s62, s26
    buffer_load_dwordx4 v246, s[32:35], s62 offen offset:0 lds
    buffer_load_dwordx4 v247, s[32:35], s62 offen offset:1024 lds
    buffer_load_dwordx4 v248, s[32:35], s62 offen offset:2048 lds
    s_add_u32 s6, s44, 4
    s_sub_u32 s7, s6, 24
    s_cselect_b32 s6, s6, s7
    s_mul_i32 s62, s6, 20480
    s_add_u32 m0, s3, 0
    s_add_u32 s62, s62, s26
    buffer_load_dwordx4 v246, s[32:35], s62 offen offset:0 lds
    buffer_load_dwordx4 v247, s[32:35], s62 offen offset:1024 lds
    buffer_load_dwordx4 v248, s[32:35], s62 offen offset:2048 lds
    s_add_u32 s6, s44, 5
    s_sub_u32 s7, s6, 24
    s_cselect_b32 s6, s6, s7
    s_mul_i32 s62, s6, 20480
    s_add_u32 m0, s3, 12288
    s_add_u32 s62, s62, s26
    buffer_load_dwordx4 v246, s[32:35], s62 offen offset:0 lds
    buffer_load_dwordx4 v247, s[32:35], s62 offen offset:1024 lds
    buffer_load_dwordx4 v248, s[32:35], s62 offen offset:2048 lds
    s_mov_b32 s5, 21037056
    s_mov_b32 s7, 400000
H_POLLB:
    buffer_load_dwordx2 v[4:5], v35, s[20:23], s5 offen sc1
    s_waitcnt vmcnt(0)
    s_setprio 2
    v_xor_b32 v4, s55, v4
    v_xor_b32 v5, s55, v5
    v_or3_b32 v4, v4, v5, v5
    v_cmp_ne_u32 vcc, 0, v4
    s_setprio 0
    s_cmp_eq_u64 vcc, 0
    s_cbranch_scc1 H_POLLB_OK
    s_sub_u32 s7, s7, 1
    s_cmp_eq_u32 s7, 0
    s_cbranch_scc1 H_POLLB_OK
    s_sleep 2
    s_branch H_POLLB
H_POLLB_OK:
    s_setprio 2
    v_and_b32 v2, 31, v0
    v_lshlrev_b32 v2, 2, v2
    s_setprio 0
    s_xor_b32 s6, s31, 128
    buffer_load_dword v36, v2, s[20:23], s31 offen sc1
    buffer_load_dword v38, v2, s[20:23], s6 offen sc1
    s_add_u32 s6, s44, 0
    s_sub_u32 s7, s6, 24
    s_cselect_b32 s6, s6, s7
    s_lshl_b32 s6, s6, 10
    s_add_u32 s62, s24, s6
    buffer_load_dwordx4 v[144:147], v252, s[20:23], s62 offen sc1
    s_add_u32 s62, s25, s6
    buffer_load_dwordx4 v[148:151], v252, s[20:23], s62 offen sc1
    s_add_u32 s6, s44, 1
    s_sub_u32 s7, s6, 24
    s_cselect_b32 s6, s6, s7
    s_lshl_b32 s6, s6, 10
    s_add_u32 s62, s24, s6
    buffer_load_dwordx4 v[152:155], v252, s[20:23], s62 offen sc1
    s_add_u32 s62, s25, s6
    buffer_load_dwordx4 v[156:159], v252, s[20:23], s62 offen sc1
    s_add_u32 s6, s44, 2
    s_sub_u32 s7, s6, 24
    s_cselect_b32 s6, s6, s7
    s_lshl_b32 s6, s6, 10
    s_add_u32 s62, s24, s6
    buffer_load_dwordx4 v[160:163], v252, s[20:23], s62 offen sc1
    s_add_u32 s62, s25, s6
    buffer_load_dwordx4 v[164:167], v252, s[20:23], s62 offen sc1
    s_add_u32 s6, s44, 3
    s_sub_u32 s7, s6, 24
    s_cselect_b32 s6, s6, s7
    s_lshl_b32 s6, s6, 10
    s_add_u32 s62, s24, s6
    buffer_load_dwordx4 v[168:171], v252, s[20:23], s62 offen sc1
    s_add_u32 s62, s25, s6
    buffer_load_dwordx4 v[172:175], v252, s[20:23], s62 offen sc1
    s_add_u32 s6, s44, 4
    s_sub_u32 s7, s6, 24
    s_cselect_b32 s6, s6, s7
    s_lshl_b32 s6, s6, 10
    s_add_u32 s62, s24, s6
    buffer_load_dwordx4 v[176:179], v252, s[20:23], s62 offen sc1
    s_add_u32 s62, s25, s6
    buffer_load_dwordx4 v[180:183], v252, s[20:23], s62 offen sc1
    s_add_u32 s6, s44, 5
    s_sub_u32 s7, s6, 24
    s_cselect_b32 s6, s6, s7
    s_lshl_b32 s6, s6, 10
    s_add_u32 s62, s24, s6
    buffer_load_dwordx4 v[184:187], v252, s[20:23], s62 offen sc1
    s_add_u32 s62, s25, s6
    buffer_load_dwordx4 v[188:191], v252, s[20:23], s62 offen sc1
    s_waitcnt vmcnt(14)
    s_barrier
    s_setprio 2
    s_lshl_b32 s7, s51, 2
    s_add_u32 s7, s7, s58
    s_mul_i32 s5, s7, 81920
    s_add_u32 s5, s5, 17825792
    s_lshl_b32 s6, s50, 10
    s_add_u32 s6, s6, s5
    v_mov_b32 v8, -1
    v_mov_b32 v9, -1
    v_mov_b32 v10, -1
    v_mov_b32 v11, -1
    v_lshrrev_b32 v2, 5, v0
    v_mul_u32_u24 v2, 40448, v2
    v_add_u32 v2, v2, v253
    buffer_store_dwordx4 v[8:11], v252, s[20:23], s6 offen sc1
    s_add_u32 s6, s6, 40960
    buffer_store_dwordx4 v[8:11], v252, s[20:23], s6 offen sc1
    s_lshl_b32 s6, s50, 8
    s_add_u32 s5, s5, s6
    s_add_u32 s5, s5, 32768
    buffer_store_dwordx2 v[8:9], v2, s[20:23], s5 offen sc1
    s_lshl_b32 s7, s7, 5
    s_add_u32 s7, s7, s50
    s_lshl_b32 s7, s7, 2
    s_add_u32 s45, s7, 21102592
    s_lshl_b32 s5, s48, 4
    s_add_u32 s5, s5, s49
    s_lshl_b32 s5, s5, 5
    s_add_u32 s5, s5, s58
    s_lshl_b32 s5, s5, 2
    s_add_u32 s46, s5, 21069824
    v_mov_b32 v15, s55
    s_setprio 0
    s_add_u32 m0, s3, 131072
    s_add_u32 s62, s61, 61440
    buffer_load_dwordx4 v240, s[20:23], s62 offen offset:0 sc1 lds
    buffer_load_dwordx4 v241, s[20:23], s62 offen offset:1024 sc1 lds
    buffer_load_dwordx4 v242, s[20:23], s62 offen offset:2048 sc1 lds
    s_add_u32 m0, s59, 131072
    s_add_u32 s62, s63, 30720
    s_mov_b32 exec_lo, 0xffcfffff
    s_mov_b32 exec_hi, 0xfffff3ff
    buffer_load_dwordx4 v243, s[20:23], s62 offen offset:0 sc1 lds
    s_mov_b32 exec_lo, 0xff3ffffc
    s_mov_b32 exec_hi, 0xffffcfff
    buffer_load_dwordx4 v244, s[20:23], s62 offen offset:1024 sc1 lds
    s_mov_b32 exec_lo, 0xfcfffff3
    s_mov_b32 exec_hi, 0x3fff
    buffer_load_dwordx4 v245, s[20:23], s62 offen offset:2048 sc1 lds
    s_mov_b64 exec, -1
    s_waitcnt vmcnt(19)
    ds_read_b64_tr_b16 v[120:121], v33 offset:16384
    ds_read_b64_tr_b16 v[122:123], v33 offset:17920
    ds_read_b64_tr_b16 v[124:125], v33 offset:16448
    ds_read_b64_tr_b16 v[126:127], v33 offset:17984
    ds_read_b64_tr_b16 v[128:129], v13 offset:16384
    ds_read_b64_tr_b16 v[130:131], v13 offset:17920
    s_waitcnt lgkmcnt(0)
    v_mfma_f32_32x32x16_bf16 v[40:55], v[120:123], v[144:147], v[40:55]
    v_mfma_f32_32x32x16_bf16 v[56:71], v[120:123], v[148:151], v[56:71]
    v_mfma_f32_32x32x16_bf16 v[72:87], v[124:127], v[144:147], v[72:87]
    v_mfma_f32_32x32x16_bf16 v[88:103], v[124:127], v[148:151], v[88:103]
    v_mfma_f32_32x32x16_bf16 v[104:119], v[128:131], v[144:147], v[104:119]
    s_add_u32 s6, s44, 6
    s_sub_u32 s7, s6, 24
    s_cselect_b32 s6, s6, s7
    s_mul_i32 s62, s6, 20480
    s_add_u32 m0, s3, 81920
    s_add_u32 s62, s62, s26
    buffer_load_dwordx4 v246, s[32:35], s62 offen offset:0 lds
    buffer_load_dwordx4 v247, s[32:35], s62 offen offset:1024 lds
    buffer_load_dwordx4 v248, s[32:35], s62 offen offset:2048 lds
    s_add_u32 s6, s44, 6
    s_sub_u32 s7, s6, 24
    s_cselect_b32 s6, s6, s7
    s_lshl_b32 s6, s6, 10
    s_add_u32 s62, s24, s6
    buffer_load_dwordx4 v[144:147], v252, s[20:23], s62 offen sc1
    s_add_u32 s62, s25, s6
    buffer_load_dwordx4 v[148:151], v252, s[20:23], s62 offen sc1
    s_waitcnt vmcnt(22)
    ds_read_b64_tr_b16 v[120:121], v33 offset:28672
    ds_read_b64_tr_b16 v[122:123], v33 offset:30208
    ds_read_b64_tr_b16 v[124:125], v33 offset:28736
    ds_read_b64_tr_b16 v[126:127], v33 offset:30272
    ds_read_b64_tr_b16 v[128:129], v13 offset:28672
    ds_read_b64_tr_b16 v[130:131], v13 offset:30208
    s_waitcnt lgkmcnt(0)
    v_mfma_f32_32x32x16_bf16 v[40:55], v[120:123], v[152:155], v[40:55]
    v_mfma_f32_32x32x16_bf16 v[56:71], v[120:123], v[156:159], v[56:71]
    v_mfma_f32_32x32x16_bf16 v[72:87], v[124:127], v[152:155], v[72:87]
    v_mfma_f32_32x32x16_bf16 v[88:103], v[124:127], v[156:159], v[88:103]
    v_mfma_f32_32x32x16_bf16 v[104:119], v[128:131], v[152:155], v[104:119]
    s_add_u32 s6, s44, 7
    s_sub_u32 s7, s6, 24
    s_cselect_b32 s6, s6, s7
    s_mul_i32 s62, s6, 20480
    s_add_u32 m0, s3, 94208
    s_add_u32 s62, s62, s26
    buffer_load_dwordx4 v246, s[32:35], s62 offen offset:0 lds
    buffer_load_dwordx4 v247, s[32:35], s62 offen offset:1024 lds
    buffer_load_dwordx4 v248, s[32:35], s62 offen offset:2048 lds
    s_add_u32 s6, s44, 7
    s_sub_u32 s7, s6, 24
    s_cselect_b32 s6, s6, s7
    s_lshl_b32 s6, s6, 10
    s_add_u32 s62, s24, s6
    buffer_load_dwordx4 v[152:155], v252, s[20:23], s62 offen sc1
    s_add_u32 s62, s25, s6
    buffer_load_dwordx4 v[156:159], v252, s[20:23], s62 offen sc1
    s_waitcnt vmcnt(25)
    ds_read_b64_tr_b16 v[120:121], v33 offset:40960
    ds_read_b64_tr_b16 v[122:123], v33 offset:42496
    ds_read_b64_tr_b16 v[124:125], v33 offset:41024
    ds_read_b64_tr_b16 v[126:127], v33 offset:42560
    ds_read_b64_tr_b16 v[128:129], v13 offset:40960
    ds_read_b64_tr_b16 v[130:131], v13 offset:42496
    s_waitcnt lgkmcnt(0)
    v_mfma_f32_32x32x16_bf16 v[40:55], v[120:123], v[160:163], v[40:55]
    v_mfma_f32_32x32x16_bf16 v[56:71], v[120:123], v[164:167], v[56:71]
    v_mfma_f32_32x32x16_bf16 v[72:87], v[124:127], v[160:163], v[72:87]
    v_mfma_f32_32x32x16_bf16 v[88:103], v[124:127], v[164:167], v[88:103]
    v_mfma_f32_32x32x16_bf16 v[104:119], v[128:131], v[160:163], v[104:119]
    s_add_u32 s6, s44, 8
    s_sub_u32 s7, s6, 24
    s_cselect_b32 s6, s6, s7
    s_mul_i32 s62, s6, 20480
    s_add_u32 m0, s3, 106496
    s_add_u32 s62, s62, s26
    buffer_load_dwordx4 v246, s[32:35], s62 offen offset:0 lds
    buffer_load_dwordx4 v247, s[32:35], s62 offen offset:1024 lds
    buffer_load_dwordx4 v248, s[32:35], s62 offen offset:2048 lds
    s_add_u32 s6, s44, 8
    s_sub_u32 s7, s6, 24
    s_cselect_b32 s6, s6, s7
    s_lshl_b32 s6, s6, 10
    s_add_u32 s62, s24, s6
    buffer_load_dwordx4 v[160:163], v252, s[20:23], s62 offen sc1
    s_add_u32 s62, s25, s6
    buffer_load_dwordx4 v[164:167], v252, s[20:23], s62 offen sc1
    s_waitcnt vmcnt(28)
    ds_read_b64_tr_b16 v[120:121], v33 offset:53248
    ds_read_b64_tr_b16 v[122:123], v33 offset:54784
    ds_read_b64_tr_b16 v[124:125], v33 offset:53312
    ds_read_b64_tr_b16 v[126:127], v33 offset:54848
    ds_read_b64_tr_b16 v[128:129], v13 offset:53248
    ds_read_b64_tr_b16 v[130:131], v13 offset:54784
    s_waitcnt lgkmcnt(0)
    v_mfma_f32_32x32x16_bf16 v[40:55], v[120:123], v[168:171], v[40:55]
    v_mfma_f32_32x32x16_bf16 v[56:71], v[120:123], v[172:175], v[56:71]
    v_mfma_f32_32x32x16_bf16 v[72:87], v[124:127], v[168:171], v[72:87]
    v_mfma_f32_32x32x16_bf16 v[88:103], v[124:127], v[172:175], v[88:103]
    v_mfma_f32_32x32x16_bf16 v[104:119], v[128:131], v[168:171], v[104:119]
    s_add_u32 s6, s44, 9
    s_sub_u32 s7, s6, 24
    s_cselect_b32 s6, s6, s7
    s_mul_i32 s62, s6, 20480
    s_add_u32 m0, s3, 118784
    s_add_u32 s62, s62, s26
    buffer_load_dwordx4 v246, s[32:35], s62 offen offset:0 lds
    buffer_load_dwordx4 v247, s[32:35], s62 offen offset:1024 lds
    buffer_load_dwordx4 v248, s[32:35], s62 offen offset:2048 lds
    s_add_u32 s6, s44, 9
    s_sub_u32 s7, s6, 24
    s_cselect_b32 s6, s6, s7
    s_lshl_b32 s6, s6, 10
    s_add_u32 s62, s24, s6
    buffer_load_dwordx4 v[168:171], v252, s[20:23], s62 offen sc1
    s_add_u32 s62, s25, s6
    buffer_load_dwordx4 v[172:175], v252, s[20:23], s62 offen sc1
    s_waitcnt vmcnt(31)
    ds_read_b64_tr_b16 v[120:121], v32 offset:0
    ds_read_b64_tr_b16 v[122:123], v32 offset:1536
    ds_read_b64_tr_b16 v[124:125], v32 offset:64
    ds_read_b64_tr_b16 v[126:127], v32 offset:1600
    ds_read_b64_tr_b16 v[128:129], v12 offset:0
    ds_read_b64_tr_b16 v[130:131], v12 offset:1536
    s_waitcnt lgkmcnt(0)
    v_mfma_f32_32x32x16_bf16 v[40:55], v[120:123], v[176:179], v[40:55]
    v_mfma_f32_32x32x16_bf16 v[56:71], v[120:123], v[180:183], v[56:71]
    v_mfma_f32_32x32x16_bf16 v[72:87], v[124:127], v[176:179], v[72:87]
    v_mfma_f32_32x32x16_bf16 v[88:103], v[124:127], v[180:183], v[88:103]
    v_mfma_f32_32x32x16_bf16 v[104:119], v[128:131], v[176:179], v[104:119]
    s_add_u32 s6, s44, 10
    s_sub_u32 s7, s6, 24
    s_cselect_b32 s6, s6, s7
    s_mul_i32 s62, s6, 20480
    s_add_u32 m0, s3, 0
    s_add_u32 s62, s62, s26
    buffer_load_dwordx4 v246, s[32:35], s62 offen offset:0 lds
    buffer_load_dwordx4 v247, s[32:35], s62 offen offset:1024 lds
    buffer_load_dwordx4 v248, s[32:35], s62 offen offset:2048 lds
    s_add_u32 s6, s44, 10
    s_sub_u32 s7, s6, 24
    s_cselect_b32 s6, s6, s7
    s_lshl_b32 s6, s6, 10
    s_add_u32 s62, s24, s6
    buffer_load_dwordx4 v[176:179], v252, s[20:23], s62 offen sc1
    s_add_u32 s62, s25, s6
    buffer_load_dwordx4 v[180:183], v252, s[20:23], s62 offen sc1
    s_waitcnt vmcnt(25)
    s_barrier
    s_mov_b64 exec, 1
    buffer_store_dword v15, off, s[20:23], s45 sc1
    s_mov_b64 exec, -1
    s_add_u32 m0, s3, 57344
    s_add_u32 s62, s61, 81920
    buffer_load_dwordx4 v240, s[20:23], s62 offen offset:0 sc1 lds
    buffer_load_dwordx4 v241, s[20:23], s62 offen offset:1024 sc1 lds
    buffer_load_dwordx4 v242, s[20:23], s62 offen offset:2048 sc1 lds
    s_add_u32 m0, s59, 57344
    s_add_u32 s62, s63, 40960
    s_mov_b32 exec_lo, 0xffcfffff
    s_mov_b32 exec_hi, 0xfffff3ff
    buffer_load_dwordx4 v243, s[20:23], s62 offen offset:0 sc1 lds
    s_mov_b32 exec_lo, 0xff3ffffc
    s_mov_b32 exec_hi, 0xffffcfff
    buffer_load_dwordx4 v244, s[20:23], s62 offen offset:1024 sc1 lds
    s_mov_b32 exec_lo, 0xfcfffff3
    s_mov_b32 exec_hi, 0x3fff
    buffer_load_dwordx4 v245, s[20:23], s62 offen offset:2048 sc1 lds
    s_mov_b64 exec, -1
    s_waitcnt vmcnt(41)
    ds_read_b64_tr_b16 v[120:121], v32 offset:12288
    ds_read_b64_tr_b16 v[122:123], v32 offset:13824
    ds_read_b64_tr_b16 v[124:125], v32 offset:12352
    ds_read_b64_tr_b16 v[126:127], v32 offset:13888
    ds_read_b64_tr_b16 v[128:129], v12 offset:12288
    ds_read_b64_tr_b16 v[130:131], v12 offset:13824
    s_waitcnt lgkmcnt(0)
    v_mfma_f32_32x32x16_bf16 v[40:55], v[120:123], v[184:187], v[40:55]
    v_mfma_f32_32x32x16_bf16 v[56:71], v[120:123], v[188:191], v[56:71]
    v_mfma_f32_32x32x16_bf16 v[72:87], v[124:127], v[184:187], v[72:87]
    v_mfma_f32_32x32x16_bf16 v[88:103], v[124:127], v[188:191], v[88:103]
    v_mfma_f32_32x32x16_bf16 v[104:119], v[128:131], v[184:187], v[104:119]
    s_add_u32 s6, s44, 11
    s_sub_u32 s7, s6, 24
    s_cselect_b32 s6, s6, s7
    s_mul_i32 s62, s6, 20480
    s_add_u32 m0, s3, 12288
    s_add_u32 s62, s62, s26
    buffer_load_dwordx4 v246, s[32:35], s62 offen offset:0 lds
    buffer_load_dwordx4 v247, s[32:35], s62 offen offset:1024 lds
    buffer_load_dwordx4 v248, s[32:35], s62 offen offset:2048 lds
    s_add_u32 s6, s44, 11
    s_sub_u32 s7, s6, 24
    s_cselect_b32 s6, s6, s7
    s_lshl_b32 s6, s6, 10
    s_add_u32 s62, s24, s6
    buffer_load_dwordx4 v[184:187], v252, s[20:23], s62 offen sc1
    s_add_u32 s62, s25, s6
    buffer_load_dwordx4 v[188:191], v252, s[20:23], s62 offen sc1
    s_waitcnt vmcnt(32)
    ds_read_b64_tr_b16 v[120:121], v33 offset:16384
    ds_read_b64_tr_b16 v[122:123], v33 offset:17920
    ds_read_b64_tr_b16 v[124:125], v33 offset:16448
    ds_read_b64_tr_b16 v[126:127], v33 offset:17984
    ds_read_b64_tr_b16 v[128:129], v13 offset:16384
    ds_read_b64_tr_b16 v[130:131], v13 offset:17920
    s_waitcnt lgkmcnt(0)
    v_mfma_f32_32x32x16_bf16 v[40:55], v[120:123], v[144:147], v[40:55]
    v_mfma_f32_32x32x16_bf16 v[56:71], v[120:123], v[148:151], v[56:71]
    v_mfma_f32_32x32x16_bf16 v[72:87], v[124:127], v[144:147], v[72:87]
    v_mfma_f32_32x32x16_bf16 v[88:103], v[124:127], v[148:151], v[88:103]
    v_mfma_f32_32x32x16_bf16 v[104:119], v[128:131], v[144:147], v[104:119]
    s_add_u32 s6, s44, 12
    s_sub_u32 s7, s6, 24
    s_cselect_b32 s6, s6, s7
    s_mul_i32 s62, s6, 20480
    s_add_u32 m0, s3, 81920
    s_add_u32 s62, s62, s26
    buffer_load_dwordx4 v246, s[32:35], s62 offen offset:0 lds
    buffer_load_dwordx4 v247, s[32:35], s62 offen offset:1024 lds
    buffer_load_dwordx4 v248, s[32:35], s62 offen offset:2048 lds
    s_add_u32 s6, s44, 12
    s_sub_u32 s7, s6, 24
    s_cselect_b32 s6, s6, s7
    s_lshl_b32 s6, s6, 10
    s_add_u32 s62, s24, s6
    buffer_load_dwordx4 v[144:147], v252, s[20:23], s62 offen sc1
    s_add_u32 s62, s25, s6
    buffer_load_dwordx4 v[148:151], v252, s[20:23], s62 offen sc1
    s_waitcnt vmcnt(32)
    ds_read_b64_tr_b16 v[120:121], v33 offset:28672
    ds_read_b64_tr_b16 v[122:123], v33 offset:30208
    ds_read_b64_tr_b16 v[124:125], v33 offset:28736
    ds_read_b64_tr_b16 v[126:127], v33 offset:30272
    ds_read_b64_tr_b16 v[128:129], v13 offset:28672
    ds_read_b64_tr_b16 v[130:131], v13 offset:30208
    s_waitcnt lgkmcnt(0)
    v_mfma_f32_32x32x16_bf16 v[40:55], v[120:123], v[152:155], v[40:55]
    v_mfma_f32_32x32x16_bf16 v[56:71], v[120:123], v[156:159], v[56:71]
    v_mfma_f32_32x32x16_bf16 v[72:87], v[124:127], v[152:155], v[72:87]
    v_mfma_f32_32x32x16_bf16 v[88:103], v[124:127], v[156:159], v[88:103]
    v_mfma_f32_32x32x16_bf16 v[104:119], v[128:131], v[152:155], v[104:119]
    s_add_u32 s6, s44, 13
    s_sub_u32 s7, s6, 24
    s_cselect_b32 s6, s6, s7
    s_mul_i32 s62, s6, 20480
    s_add_u32 m0, s3, 94208
    s_add_u32 s62, s62, s26
    buffer_load_dwordx4 v246, s[32:35], s62 offen offset:0 lds
    buffer_load_dwordx4 v247, s[32:35], s62 offen offset:1024 lds
    buffer_load_dwordx4 v248, s[32:35], s62 offen offset:2048 lds
    s_add_u32 s6, s44, 13
    s_sub_u32 s7, s6, 24
    s_cselect_b32 s6, s6, s7
    s_lshl_b32 s6, s6, 10
    s_add_u32 s62, s24, s6
    buffer_load_dwordx4 v[152:155], v252, s[20:23], s62 offen sc1
    s_add_u32 s62, s25, s6
    buffer_load_dwordx4 v[156:159], v252, s[20:23], s62 offen sc1
    s_waitcnt vmcnt(32)
    ds_read_b64_tr_b16 v[120:121], v33 offset:40960
    ds_read_b64_tr_b16 v[122:123], v33 offset:42496
    ds_read_b64_tr_b16 v[124:125], v33 offset:41024
    ds_read_b64_tr_b16 v[126:127], v33 offset:42560
    ds_read_b64_tr_b16 v[128:129], v13 offset:40960
    ds_read_b64_tr_b16 v[130:131], v13 offset:42496
    s_waitcnt lgkmcnt(0)
    v_mfma_f32_32x32x16_bf16 v[40:55], v[120:123], v[160:163], v[40:55]
    v_mfma_f32_32x32x16_bf16 v[56:71], v[120:123], v[164:167], v[56:71]
    v_mfma_f32_32x32x16_bf16 v[72:87], v[124:127], v[160:163], v[72:87]
    v_mfma_f32_32x32x16_bf16 v[88:103], v[124:127], v[164:167], v[88:103]
    v_mfma_f32_32x32x16_bf16 v[104:119], v[128:131], v[160:163], v[104:119]
    s_add_u32 s6, s44, 14
    s_sub_u32 s7, s6, 24
    s_cselect_b32 s6, s6, s7
    s_mul_i32 s62, s6, 20480
    s_add_u32 m0, s3, 106496
    s_add_u32 s62, s62, s26
    buffer_load_dwordx4 v246, s[32:35], s62 offen offset:0 lds
    buffer_load_dwordx4 v247, s[32:35], s62 offen offset:1024 lds
    buffer_load_dwordx4 v248, s[32:35], s62 offen offset:2048 lds
    s_add_u32 s6, s44, 14
    s_sub_u32 s7, s6, 24
    s_cselect_b32 s6, s6, s7
    s_lshl_b32 s6, s6, 10
    s_add_u32 s62, s24, s6
    buffer_load_dwordx4 v[160:163], v252, s[20:23], s62 offen sc1
    s_add_u32 s62, s25, s6
    buffer_load_dwordx4 v[164:167], v252, s[20:23], s62 offen sc1
    s_waitcnt vmcnt(32)
    ds_read_b64_tr_b16 v[120:121], v33 offset:53248
    ds_read_b64_tr_b16 v[122:123], v33 offset:54784
    ds_read_b64_tr_b16 v[124:125], v33 offset:53312
    ds_read_b64_tr_b16 v[126:127], v33 offset:54848
    ds_read_b64_tr_b16 v[128:129], v13 offset:53248
    ds_read_b64_tr_b16 v[130:131], v13 offset:54784
    s_waitcnt lgkmcnt(0)
    v_mfma_f32_32x32x16_bf16 v[40:55], v[120:123], v[168:171], v[40:55]
    v_mfma_f32_32x32x16_bf16 v[56:71], v[120:123], v[172:175], v[56:71]
    v_mfma_f32_32x32x16_bf16 v[72:87], v[124:127], v[168:171], v[72:87]
    v_mfma_f32_32x32x16_bf16 v[88:103], v[124:127], v[172:175], v[88:103]
    v_mfma_f32_32x32x16_bf16 v[104:119], v[128:131], v[168:171], v[104:119]
    s_add_u32 s6, s44, 15
    s_sub_u32 s7, s6, 24
    s_cselect_b32 s6, s6, s7
    s_mul_i32 s62, s6, 20480
    s_add_u32 m0, s3, 118784
    s_add_u32 s62, s62, s26
    buffer_load_dwordx4 v246, s[32:35], s62 offen offset:0 lds
    buffer_load_dwordx4 v247, s[32:35], s62 offen offset:1024 lds
    buffer_load_dwordx4 v248, s[32:35], s62 offen offset:2048 lds
    s_add_u32 s6, s44, 15
    s_sub_u32 s7, s6, 24
    s_cselect_b32 s6, s6, s7
    s_lshl_b32 s6, s6, 10
    s_add_u32 s62, s24, s6
    buffer_load_dwordx4 v[168:171], v252, s[20:23], s62 offen sc1
    s_add_u32 s62, s25, s6
    buffer_load_dwordx4 v[172:175], v252, s[20:23], s62 offen sc1
    s_waitcnt vmcnt(25)
    s_barrier
    s_lshl_b32 s5, s52, 7
    s_lshl_b32 s6, s58, 5
    s_add_u32 s5, s5, s6
    s_add_u32 s5, s5, 21102592
    s_setprio 2
    v_and_b32 v3, 7, v0
    v_lshlrev_b32 v3, 2, v3
    s_setprio 0
    buffer_load_dword v6, v3, s[20:23], s5 offen sc1
    s_add_u32 m0, s3, 32768
    s_add_u32 s62, s61, 102400
    buffer_load_dwordx4 v240, s[20:23], s62 offen offset:0 sc1 lds
    buffer_load_dwordx4 v241, s[20:23], s62 offen offset:1024 sc1 lds
    buffer_load_dwordx4 v242, s[20:23], s62 offen offset:2048 sc1 lds
    s_add_u32 m0, s59, 32768
    s_add_u32 s62, s63, 51200
    s_mov_b32 exec_lo, 0xffcfffff
    s_mov_b32 exec_hi, 0xfffff3ff
    buffer_load_dwordx4 v243, s[20:23], s62 offen offset:0 sc1 lds
    s_mov_b32 exec_lo, 0xff3ffffc
    s_mov_b32 exec_hi, 0xffffcfff
    buffer_load_dwordx4 v244, s[20:23], s62 offen offset:1024 sc1 lds
    s_mov_b32 exec_lo, 0xfcfffff3
    s_mov_b32 exec_hi, 0x3fff
    buffer_load_dwordx4 v245, s[20:23], s62 offen offset:2048 sc1 lds
    s_mov_b64 exec, -1
    s_waitcnt vmcnt(39)
    ds_read_b64_tr_b16 v[120:121], v32 offset:0
    ds_read_b64_tr_b16 v[122:123], v32 offset:1536
    ds_read_b64_tr_b16 v[124:125], v32 offset:64
    ds_read_b64_tr_b16 v[126:127], v32 offset:1600
    ds_read_b64_tr_b16 v[128:129], v12 offset:0
    ds_read_b64_tr_b16 v[130:131], v12 offset:1536
    s_waitcnt lgkmcnt(0)
    v_mfma_f32_32x32x16_bf16 v[40:55], v[120:123], v[176:179], v[40:55]
    v_mfma_f32_32x32x16_bf16 v[56:71], v[120:123], v[180:183], v[56:71]
    v_mfma_f32_32x32x16_bf16 v[72:87], v[124:127], v[176:179], v[72:87]
    v_mfma_f32_32x32x16_bf16 v[88:103], v[124:127], v[180:183], v[88:103]
    v_mfma_f32_32x32x16_bf16 v[104:119], v[128:131], v[176:179], v[104:119]
    s_add_u32 s6, s44, 16
    s_sub_u32 s7, s6, 24
    s_cselect_b32 s6, s6, s7
    s_mul_i32 s62, s6, 20480
    s_add_u32 m0, s3, 0
    s_add_u32 s62, s62, s26
    buffer_load_dwordx4 v246, s[32:35], s62 offen offset:0 lds
    buffer_load_dwordx4 v247, s[32:35], s62 offen offset:1024 lds
    buffer_load_dwordx4 v248, s[32:35], s62 offen offset:2048 lds
    s_add_u32 s6, s44, 16
    s_sub_u32 s7, s6, 24
    s_cselect_b32 s6, s6, s7
    s_lshl_b32 s6, s6, 10
    s_add_u32 s62, s24, s6
    buffer_load_dwordx4 v[176:179], v252, s[20:23], s62 offen sc1
    s_add_u32 s62, s25, s6
    buffer_load_dwordx4 v[180:183], v252, s[20:23], s62 offen sc1
    s_waitcnt vmcnt(32)
    ds_read_b64_tr_b16 v[120:121], v32 offset:12288
    ds_read_b64_tr_b16 v[122:123], v32 offset:13824
    ds_read_b64_tr_b16 v[124:125], v32 offset:12352
    ds_read_b64_tr_b16 v[126:127], v32 offset:13888
    ds_read_b64_tr_b16 v[128:129], v12 offset:12288
    ds_read_b64_tr_b16 v[130:131], v12 offset:13824
    s_waitcnt lgkmcnt(0)
    v_mfma_f32_32x32x16_bf16 v[40:55], v[120:123], v[184:187], v[40:55]
    v_mfma_f32_32x32x16_bf16 v[56:71], v[120:123], v[188:191], v[56:71]
    v_mfma_f32_32x32x16_bf16 v[72:87], v[124:127], v[184:187], v[72:87]
    v_mfma_f32_32x32x16_bf16 v[88:103], v[124:127], v[188:191], v[88:103]
    v_mfma_f32_32x32x16_bf16 v[104:119], v[128:131], v[184:187], v[104:119]
    s_add_u32 s6, s44, 17
    s_sub_u32 s7, s6, 24
    s_cselect_b32 s6, s6, s7
    s_mul_i32 s62, s6, 20480
    s_add_u32 m0, s3, 12288
    s_add_u32 s62, s62, s26
    buffer_load_dwordx4 v246, s[32:35], s62 offen offset:0 lds
    buffer_load_dwordx4 v247, s[32:35], s62 offen offset:1024 lds
    buffer_load_dwordx4 v248, s[32:35], s62 offen offset:2048 lds
    s_add_u32 s6, s44, 17
    s_sub_u32 s7, s6, 24
    s_cselect_b32 s6, s6, s7
    s_lshl_b32 s6, s6, 10
    s_add_u32 s62, s24, s6
    buffer_load_dwordx4 v[184:187], v252, s[20:23], s62 offen sc1
    s_add_u32 s62, s25, s6
    buffer_load_dwordx4 v[188:191], v252, s[20:23], s62 offen sc1
    s_waitcnt vmcnt(32)
    ds_read_b64_tr_b16 v[120:121], v33 offset:16384
    ds_read_b64_tr_b16 v[122:123], v33 offset:17920
    ds_read_b64_tr_b16 v[124:125], v33 offset:16448
    ds_read_b64_tr_b16 v[126:127], v33 offset:17984
    ds_read_b64_tr_b16 v[128:129], v13 offset:16384
    ds_read_b64_tr_b16 v[130:131], v13 offset:17920
    s_waitcnt lgkmcnt(0)
    v_mfma_f32_32x32x16_bf16 v[40:55], v[120:123], v[144:147], v[40:55]
    v_mfma_f32_32x32x16_bf16 v[56:71], v[120:123], v[148:151], v[56:71]
    v_mfma_f32_32x32x16_bf16 v[72:87], v[124:127], v[144:147], v[72:87]
    v_mfma_f32_32x32x16_bf16 v[88:103], v[124:127], v[148:151], v[88:103]
    v_mfma_f32_32x32x16_bf16 v[104:119], v[128:131], v[144:147], v[104:119]
    s_add_u32 s6, s44, 18
    s_sub_u32 s7, s6, 24
    s_cselect_b32 s6, s6, s7
    s_mul_i32 s62, s6, 20480
    s_add_u32 m0, s3, 81920
    s_add_u32 s62, s62, s26
    buffer_load_dwordx4 v246, s[32:35], s62 offen offset:0 lds
    buffer_load_dwordx4 v247, s[32:35], s62 offen offset:1024 lds
    buffer_load_dwordx4 v248, s[32:35], s62 offen offset:2048 lds
    s_add_u32 s6, s44, 18
    s_sub_u32 s7, s6, 24
    s_cselect_b32 s6, s6, s7
    s_lshl_b32 s6, s6, 10
    s_add_u32 s62, s24, s6
    buffer_load_dwordx4 v[144:147], v252, s[20:23], s62 offen sc1
    s_add_u32 s62, s25, s6
    buffer_load_dwordx4 v[148:151], v252, s[20:23], s62 offen sc1
    s_waitcnt vmcnt(32)
    ds_read_b64_tr_b16 v[120:121], v33 offset:28672
    ds_read_b64_tr_b16 v[122:123], v33 offset:30208
    ds_read_b64_tr_b16 v[124:125], v33 offset:28736
    ds_read_b64_tr_b16 v[126:127], v33 offset:30272
    ds_read_b64_tr_b16 v[128:129], v13 offset:28672
    ds_read_b64_tr_b16 v[130:131], v13 offset:30208
    s_waitcnt lgkmcnt(0)
    v_mfma_f32_32x32x16_bf16 v[40:55], v[120:123], v[152:155], v[40:55]
    v_mfma_f32_32x32x16_bf16 v[56:71], v[120:123], v[156:159], v[56:71]
    v_mfma_f32_32x32x16_bf16 v[72:87], v[124:127], v[152:155], v[72:87]
    v_mfma_f32_32x32x16_bf16 v[88:103], v[124:127], v[156:159], v[88:103]
    v_mfma_f32_32x32x16_bf16 v[104:119], v[128:131], v[152:155], v[104:119]
    s_add_u32 s6, s44, 19
    s_sub_u32 s7, s6, 24
    s_cselect_b32 s6, s6, s7
    s_mul_i32 s62, s6, 20480
    s_add_u32 m0, s3, 94208
    s_add_u32 s62, s62, s26
    buffer_load_dwordx4 v246, s[32:35], s62 offen offset:0 lds
    buffer_load_dwordx4 v247, s[32:35], s62 offen offset:1024 lds
    buffer_load_dwordx4 v248, s[32:35], s62 offen offset:2048 lds
    s_add_u32 s6, s44, 19
    s_sub_u32 s7, s6, 24
    s_cselect_b32 s6, s6, s7
    s_lshl_b32 s6, s6, 10
    s_add_u32 s62, s24, s6
    buffer_load_dwordx4 v[152:155], v252, s[20:23], s62 offen sc1
    s_add_u32 s62, s25, s6
    buffer_load_dwordx4 v[156:159], v252, s[20:23], s62 offen sc1
    s_waitcnt vmcnt(32)
    ds_read_b64_tr_b16 v[120:121], v33 offset:40960
    ds_read_b64_tr_b16 v[122:123], v33 offset:42496
    ds_read_b64_tr_b16 v[124:125], v33 offset:41024
    ds_read_b64_tr_b16 v[126:127], v33 offset:42560
    ds_read_b64_tr_b16 v[128:129], v13 offset:40960
    ds_read_b64_tr_b16 v[130:131], v13 offset:42496
    s_waitcnt lgkmcnt(0)
    v_mfma_f32_32x32x16_bf16 v[40:55], v[120:123], v[160:163], v[40:55]
    v_mfma_f32_32x32x16_bf16 v[56:71], v[120:123], v[164:167], v[56:71]
    v_mfma_f32_32x32x16_bf16 v[72:87], v[124:127], v[160:163], v[72:87]
    v_mfma_f32_32x32x16_bf16 v[88:103], v[124:127], v[164:167], v[88:103]
    v_mfma_f32_32x32x16_bf16 v[104:119], v[128:131], v[160:163], v[104:119]
    s_add_u32 s6, s44, 20
    s_sub_u32 s7, s6, 24
    s_cselect_b32 s6, s6, s7
    s_mul_i32 s62, s6, 20480
    s_add_u32 m0, s3, 106496
    s_add_u32 s62, s62, s26
    buffer_load_dwordx4 v246, s[32:35], s62 offen offset:0 lds
    buffer_load_dwordx4 v247, s[32:35], s62 offen offset:1024 lds
    buffer_load_dwordx4 v248, s[32:35], s62 offen offset:2048 lds
    s_add_u32 s6, s44, 20
    s_sub_u32 s7, s6, 24
    s_cselect_b32 s6, s6, s7
    s_lshl_b32 s6, s6, 10
    s_add_u32 s62, s24, s6
    buffer_load_dwordx4 v[160:163], v252, s[20:23], s62 offen sc1
    s_add_u32 s62, s25, s6
    buffer_load_dwordx4 v[164:167], v252, s[20:23], s62 offen sc1
    s_waitcnt vmcnt(25)
    s_barrier
    s_setprio 2
    v_xor_b32 v6, s55, v6
    v_cmp_ne_u32 vcc, 0, v6
    s_setprio 0
    s_cmp_lg_u64 vcc, 0
    s_cbranch_scc1 H_POLLP_SLOW
H_POLLP_BACK:
    s_add_u32 m0, s3, 131072
    s_add_u32 s62, s61, 122880
    buffer_load_dwordx4 v240, s[20:23], s62 offen offset:0 sc1 lds
    buffer_load_dwordx4 v241, s[20:23], s62 offen offset:1024 sc1 lds
    buffer_load_dwordx4 v242, s[20:23], s62 offen offset:2048 sc1 lds
    s_add_u32 m0, s59, 131072
    s_add_u32 s62, s63, 61440
    s_mov_b32 exec_lo, 0xffcfffff
    s_mov_b32 exec_hi, 0xfffff3ff
    buffer_load_dwordx4 v243, s[20:23], s62 offen offset:0 sc1 lds
    s_mov_b32 exec_lo, 0xff3ffffc
    s_mov_b32 exec_hi, 0xffffcfff
    buffer_load_dwordx4 v244, s[20:23], s62 offen offset:1024 sc1 lds
    s_mov_b32 exec_lo, 0xfcfffff3
    s_mov_b32 exec_hi, 0x3fff
    buffer_load_dwordx4 v245, s[20:23], s62 offen offset:2048 sc1 lds
    s_mov_b64 exec, -1
    s_waitcnt vmcnt(38)
    ds_read_b64_tr_b16 v[120:121], v33 offset:53248
    ds_read_b64_tr_b16 v[122:123], v33 offset:54784
    ds_read_b64_tr_b16 v[124:125], v33 offset:53312
    ds_read_b64_tr_b16 v[126:127], v33 offset:54848
    ds_read_b64_tr_b16 v[128:129], v13 offset:53248
    ds_read_b64_tr_b16 v[130:131], v13 offset:54784
    s_waitcnt lgkmcnt(0)
    v_mfma_f32_32x32x16_bf16 v[40:55], v[120:123], v[168:171], v[40:55]
    v_mfma_f32_32x32x16_bf16 v[56:71], v[120:123], v[172:175], v[56:71]
    v_mfma_f32_32x32x16_bf16 v[72:87], v[124:127], v[168:171], v[72:87]
    v_mfma_f32_32x32x16_bf16 v[88:103], v[124:127], v[172:175], v[88:103]
    v_mfma_f32_32x32x16_bf16 v[104:119], v[128:131], v[168:171], v[104:119]
    s_add_u32 s6, s44, 21
    s_sub_u32 s7, s6, 24
    s_cselect_b32 s6, s6, s7
    s_mul_i32 s62, s6, 20480
    s_add_u32 m0, s3, 118784
    s_add_u32 s62, s62, s26
    buffer_load_dwordx4 v246, s[32:35], s62 offen offset:0 lds
    buffer_load_dwordx4 v247, s[32:35], s62 offen offset:1024 lds
    buffer_load_dwordx4 v248, s[32:35], s62 offen offset:2048 lds
    s_add_u32 s6, s44, 21
    s_sub_u32 s7, s6, 24
    s_cselect_b32 s6, s6, s7
    s_lshl_b32 s6, s6, 10
    s_add_u32 s62, s24, s6
    buffer_load_dwordx4 v[168:171], v252, s[20:23], s62 offen sc1
    s_add_u32 s62, s25, s6
    buffer_load_dwordx4 v[172:175], v252, s[20:23], s62 offen sc1
    s_waitcnt vmcnt(31)
    ds_read_b64_tr_b16 v[120:121], v32 offset:0
    ds_read_b64_tr_b16 v[122:123], v32 offset:1536
    ds_read_b64_tr_b16 v[124:125], v32 offset:64
    ds_read_b64_tr_b16 v[126:127], v32 offset:1600
    ds_read_b64_tr_b16 v[128:129], v12 offset:0
    ds_read_b64_tr_b16 v[130:131], v12 offset:1536
    s_waitcnt lgkmcnt(0)
    v_mfma_f32_32x32x16_bf16 v[40:55], v[120:123], v[176:179], v[40:55]
    v_mfma_f32_32x32x16_bf16 v[56:71], v[120:123], v[180:183], v[56:71]
    v_mfma_f32_32x32x16_bf16 v[72:87], v[124:127], v[176:179], v[72:87]
    v_mfma_f32_32x32x16_bf16 v[88:103], v[124:127], v[180:183], v[88:103]
    v_mfma_f32_32x32x16_bf16 v[104:119], v[128:131], v[176:179], v[104:119]
    s_add_u32 s6, s44, 22
    s_sub_u32 s7, s6, 24
    s_cselect_b32 s6, s6, s7
    s_mul_i32 s62, s6, 20480
    s_add_u32 m0, s3, 0
    s_add_u32 s62, s62, s26
    buffer_load_dwordx4 v246, s[32:35], s62 offen offset:0 lds
    buffer_load_dwordx4 v247, s[32:35], s62 offen offset:1024 lds
    buffer_load_dwordx4 v248, s[32:35], s62 offen offset:2048 lds
    s_add_u32 s6, s44, 22
    s_sub_u32 s7, s6, 24
    s_cselect_b32 s6, s6, s7
    s_lshl_b32 s6, s6, 10
    s_add_u32 s62, s24, s6
    buffer_load_dwordx4 v[176:179], v252, s[20:23], s62 offen sc1
    s_add_u32 s62, s25, s6
    buffer_load_dwordx4 v[180:183], v252, s[20:23], s62 offen sc1
    s_waitcnt vmcnt(31)
    ds_read_b64_tr_b16 v[120:121], v32 offset:12288
    ds_read_b64_tr_b16 v[122:123], v32 offset:13824
    ds_read_b64_tr_b16 v[124:125], v32 offset:12352
    ds_read_b64_tr_b16 v[126:127], v32 offset:13888
    ds_read_b64_tr_b16 v[128:129], v12 offset:12288
    ds_read_b64_tr_b16 v[130:131], v12 offset:13824
    s_waitcnt lgkmcnt(0)
    v_mfma_f32_32x32x16_bf16 v[40:55], v[120:123], v[184:187], v[40:55]
    v_mfma_f32_32x32x16_bf16 v[56:71], v[120:123], v[188:191], v[56:71]
    v_mfma_f32_32x32x16_bf16 v[72:87], v[124:127], v[184:187], v[72:87]
    v_mfma_f32_32x32x16_bf16 v[88:103], v[124:127], v[188:191], v[88:103]
    v_mfma_f32_32x32x16_bf16 v[104:119], v[128:131], v[184:187], v[104:119]
    s_add_u32 s6, s44, 23
    s_sub_u32 s7, s6, 24
    s_cselect_b32 s6, s6, s7
    s_mul_i32 s62, s6, 20480
    s_add_u32 m0, s3, 12288
    s_add_u32 s62, s62, s26
    buffer_load_dwordx4 v246, s[32:35], s62 offen offset:0 lds
    buffer_load_dwordx4 v247, s[32:35], s62 offen offset:1024 lds
    buffer_load_dwordx4 v248, s[32:35], s62 offen offset:2048 lds
    s_add_u32 s6, s44, 23
    s_sub_u32 s7, s6, 24
    s_cselect_b32 s6, s6, s7
    s_lshl_b32 s6, s6, 10
    s_add_u32 s62, s24, s6
    buffer_load_dwordx4 v[184:187], v252, s[20:23], s62 offen sc1
    s_add_u32 s62, s25, s6
    buffer_load_dwordx4 v[188:191], v252, s[20:23], s62 offen sc1
    s_waitcnt vmcnt(31)
    ds_read_b64_tr_b16 v[192:193], v33 offset:16384
    ds_read_b64_tr_b16 v[194:195], v33 offset:17920
    ds_read_b64_tr_b16 v[196:197], v33 offset:16448
    ds_read_b64_tr_b16 v[198:199], v33 offset:17984
    ds_read_b64_tr_b16 v[200:201], v13 offset:16384
    ds_read_b64_tr_b16 v[202:203], v13 offset:17920
    s_waitcnt lgkmcnt(0)
    s_add_u32 m0, s3, 81920
    s_add_u32 s62, s27, 102400
    buffer_load_dwordx4 v246, s[36:39], s62 offen offset:0 lds
    buffer_load_dwordx4 v247, s[36:39], s62 offen offset:1024 lds
    buffer_load_dwordx4 v248, s[36:39], s62 offen offset:2048 lds
    s_waitcnt vmcnt(29)
    ds_read_b64_tr_b16 v[204:205], v33 offset:28672
    ds_read_b64_tr_b16 v[206:207], v33 offset:30208
    ds_read_b64_tr_b16 v[208:209], v33 offset:28736
    ds_read_b64_tr_b16 v[210:211], v33 offset:30272
    ds_read_b64_tr_b16 v[212:213], v13 offset:28672
    ds_read_b64_tr_b16 v[214:215], v13 offset:30208
    s_waitcnt lgkmcnt(0)
    s_add_u32 m0, s3, 94208
    s_add_u32 s62, s27, 128000
    buffer_load_dwordx4 v246, s[36:39], s62 offen offset:0 lds
    buffer_load_dwordx4 v247, s[36:39], s62 offen offset:1024 lds
    buffer_load_dwordx4 v248, s[36:39], s62 offen offset:2048 lds
    s_waitcnt vmcnt(21)
    s_barrier
    s_add_u32 m0, s3, 57344
    s_add_u32 s62, s61, 143360
    buffer_load_dwordx4 v240, s[20:23], s62 offen offset:0 sc1 lds
    buffer_load_dwordx4 v241, s[20:23], s62 offen offset:1024 sc1 lds
    buffer_load_dwordx4 v242, s[20:23], s62 offen offset:2048 sc1 lds
    s_add_u32 m0, s59, 57344
    s_add_u32 s62, s63, 71680
    s_mov_b32 exec_lo, 0xffcfffff
    s_mov_b32 exec_hi, 0xfffff3ff
    buffer_load_dwordx4 v243, s[20:23], s62 offen offset:0 sc1 lds
    s_mov_b32 exec_lo, 0xff3ffffc
    s_mov_b32 exec_hi, 0xffffcfff
    buffer_load_dwordx4 v244, s[20:23], s62 offen offset:1024 sc1 lds
    s_mov_b32 exec_lo, 0xfcfffff3
    s_mov_b32 exec_hi, 0x3fff
    buffer_load_dwordx4 v245, s[20:23], s62 offen offset:2048 sc1 lds
    s_mov_b64 exec, -1
    s_waitcnt vmcnt(33)
    ds_read_b64_tr_b16 v[216:217], v33 offset:40960
    ds_read_b64_tr_b16 v[218:219], v33 offset:42496
    ds_read_b64_tr_b16 v[220:221], v33 offset:41024
    ds_read_b64_tr_b16 v[222:223], v33 offset:42560
    ds_read_b64_tr_b16 v[224:225], v13 offset:40960
    ds_read_b64_tr_b16 v[226:227], v13 offset:42496
    s_waitcnt lgkmcnt(0)
    s_add_u32 m0, s3, 106496
    s_add_u32 s62, s27, 153600
    buffer_load_dwordx4 v246, s[36:39], s62 offen offset:0 lds
    buffer_load_dwordx4 v247, s[36:39], s62 offen offset:1024 lds
    buffer_load_dwordx4 v248, s[36:39], s62 offen offset:2048 lds
    s_waitcnt vmcnt(25)
    ds_read_b64_tr_b16 v[228:229], v33 offset:53248
    ds_read_b64_tr_b16 v[230:231], v33 offset:54784
    ds_read_b64_tr_b16 v[232:233], v33 offset:53312
    ds_read_b64_tr_b16 v[234:235], v33 offset:54848
    ds_read_b64_tr_b16 v[236:237], v13 offset:53248
    ds_read_b64_tr_b16 v[238:239], v13 offset:54784
    s_waitcnt lgkmcnt(0)
    s_add_u32 m0, s3, 118784
    s_add_u32 s62, s27, 179200
    buffer_load_dwordx4 v246, s[36:39], s62 offen offset:0 lds
    buffer_load_dwordx4 v247, s[36:39], s62 offen offset:1024 lds
    buffer_load_dwordx4 v248, s[36:39], s62 offen offset:2048 lds
    s_waitcnt vmcnt(23)
    ds_read_b64_tr_b16 v[132:133], v32 offset:0
    ds_read_b64_tr_b16 v[134:135], v32 offset:1536
    ds_read_b64_tr_b16 v[136:137], v32 offset:64
    ds_read_b64_tr_b16 v[138:139], v32 offset:1600
    ds_read_b64_tr_b16 v[140:141], v12 offset:0
    ds_read_b64_tr_b16 v[142:143], v12 offset:1536
    s_waitcnt lgkmcnt(0)
    s_add_u32 m0, s3, 0
    s_add_u32 s62, s27, 0
    buffer_load_dwordx4 v246, s[36:39], s62 offen offset:0 lds
    buffer_load_dwordx4 v247, s[36:39], s62 offen offset:1024 lds
    buffer_load_dwordx4 v248, s[36:39], s62 offen offset:2048 lds
    s_waitcnt vmcnt(21)
    ds_read_b64_tr_b16 v[120:121], v32 offset:12288
    ds_read_b64_tr_b16 v[122:123], v32 offset:13824
    ds_read_b64_tr_b16 v[124:125], v32 offset:12352
    ds_read_b64_tr_b16 v[126:127], v32 offset:13888
    ds_read_b64_tr_b16 v[128:129], v12 offset:12288
    ds_read_b64_tr_b16 v[130:131], v12 offset:13824
    s_waitcnt lgkmcnt(0)
    s_add_u32 m0, s3, 12288
    s_add_u32 s62, s27, 25600
    buffer_load_dwordx4 v246, s[36:39], s62 offen offset:0 lds
    buffer_load_dwordx4 v247, s[36:39], s62 offen offset:1024 lds
    buffer_load_dwordx4 v248, s[36:39], s62 offen offset:2048 lds
    v_lshrrev_b32 v4, 3, v0
    v_mul_u32_u24 v4, 20, v4
    v_bfe_u32 v5, v0, 1, 2
    v_add3_u32 v4, v4, v5, 16
    v_mul_u32_u24 v4, 1280, v4
    v_and_b32 v5, 1, v0
    v_lshl_add_u32 v4, v5, 7, v4
    s_lshr_b32 s5, s53, 1
    s_mul_i32 s5, s5, 320
    s_lshl_b32 s6, s30, 7
    s_add_u32 s5, s5, s6
    s_and_b32 s5, s5, 0xffffff80
    s_add_u32 s5, s5, s27
    buffer_load_dword v7, v4, s[36:39], s5 offen
    s_waitcnt vmcnt(13)
    s_barrier
    s_add_u32 m0, s3, 24576
    s_add_u32 s62, s27, 51200
    buffer_load_dwordx4 v246, s[36:39], s62 offen offset:0 lds
    buffer_load_dwordx4 v247, s[36:39], s62 offen offset:1024 lds
    buffer_load_dwordx4 v248, s[36:39], s62 offen offset:2048 lds
    s_add_u32 m0, s3, 36864
    s_add_u32 s62, s27, 76800
    buffer_load_dwordx4 v246, s[36:39], s62 offen offset:0 lds
    buffer_load_dwordx4 v247, s[36:39], s62 offen offset:1024 lds
    buffer_load_dwordx4 v248, s[36:39], s62 offen offset:2048 lds
    v_and_b32 v3, 7, v0
    v_lshlrev_b32 v3, 10, v3
    s_lshl_b32 s6, s58, 13
    s_add_u32 s24, s28, s6
    s_add_u32 s25, s29, s6
    s_lshl_b32 s6, s58, 11
    s_add_u32 s6, s6, 32768
    s_add_u32 s28, s28, s6
    s_add_u32 s29, s29, s6
    v_bfe_u32 v4, v0, 4, 1
    v_and_b32 v5, 15, v0
    v_lshrrev_b32 v6, 5, v0
    v_mul_u32_u24 v4, 12288, v4
    v_mul_u32_u24 v5, 144, v5
    v_lshl_add_u32 v5, v6, 4, v5
    v_add3_u32 v24, v4, v5, s3
    v_add_u32 v25, 81920, v24
    v_lshrrev_b32 v4, 2, v0
    v_and_b32 v5, 3, v0
    v_mul_u32_u24 v6, 144, v4
    v_lshl_add_u32 v6, v5, 5, v6
    s_and_b32 s5, s58, 1
    s_mul_i32 s6, s5, 12288
    s_lshr_b32 s7, s58, 1
    s_mul_i32 s46, s7, 24576
    s_add_u32 s46, s46, s6
    v_add_u32 v26, s46, v6
    v_add_u32 v27, 81920, v26
    s_add_u32 s6, s6, 131072
    v_add_u32 v29, s6, v6
    s_lshl_b32 s5, s5, 4
    v_add_u32 v4, s5, v4
    v_mul_u32_u24 v4, 1280, v4
    v_lshl_add_u32 v28, v5, 4, v4
    s_and_b32 s46, s53, 1
    s_lshl_b32 s5, s52, 1
    s_add_u32 s5, s5, s46
    s_xor_b32 s6, s5, s7
    s_mul_i32 s5, s5, 40960
    s_mul_i32 s6, s6, 40960
    s_lshr_b32 s7, s53, 1
    s_mul_i32 s7, s7, 320
    s_add_u32 s5, s5, s7
    s_add_u32 s6, s6, s7
    s_add_u32 s18, s5, 128
    s_mul_i32 s7, s46, 192
    s_add_u32 s16, s6, s7
    s_add_u32 s17, s16, 64
    s_barrier
    s_add_u32 m0, s3, 131072
    s_add_u32 s62, s27, 0
    buffer_load_dwordx4 v249, s[36:39], s62 offen offset:0 lds
    buffer_load_dwordx4 v250, s[36:39], s62 offen offset:1024 lds
    buffer_load_dwordx4 v251, s[36:39], s62 offen offset:2048 lds
    s_add_u32 m0, s3, 143360
    s_add_u32 s62, s27, 102400
    buffer_load_dwordx4 v249, s[36:39], s62 offen offset:0 lds
    buffer_load_dwordx4 v250, s[36:39], s62 offen offset:1024 lds
    buffer_load_dwordx4 v251, s[36:39], s62 offen offset:2048 lds
    s_barrier
    v_mfma_f32_32x32x16_bf16 v[40:55], v[192:195], v[144:147], v[40:55]
    v_mfma_f32_32x32x16_bf16 v[56:71], v[192:195], v[148:151], v[56:71]
    v_mfma_f32_32x32x16_bf16 v[72:87], v[196:199], v[144:147], v[72:87]
    v_mfma_f32_32x32x16_bf16 v[88:103], v[196:199], v[148:151], v[88:103]
    v_mfma_f32_32x32x16_bf16 v[104:119], v[200:203], v[144:147], v[104:119]
    v_mfma_f32_32x32x16_bf16 v[40:55], v[204:207], v[152:155], v[40:55]
    v_mfma_f32_32x32x16_bf16 v[56:71], v[204:207], v[156:159], v[56:71]
    v_mfma_f32_32x32x16_bf16 v[72:87], v[208:211], v[152:155], v[72:87]
    v_mfma_f32_32x32x16_bf16 v[88:103], v[208:211], v[156:159], v[88:103]
    v_mfma_f32_32x32x16_bf16 v[104:119], v[212:215], v[152:155], v[104:119]
    v_mfma_f32_32x32x16_bf16 v[40:55], v[216:219], v[160:163], v[40:55]
    v_mfma_f32_32x32x16_bf16 v[56:71], v[216:219], v[164:167], v[56:71]
    v_mfma_f32_32x32x16_bf16 v[72:87], v[220:223], v[160:163], v[72:87]
    v_mfma_f32_32x32x16_bf16 v[88:103], v[220:223], v[164:167], v[88:103]
    v_mfma_f32_32x32x16_bf16 v[104:119], v[224:227], v[160:163], v[104:119]
    v_mfma_f32_32x32x16_bf16 v[40:55], v[228:231], v[168:171], v[40:55]
    v_mfma_f32_32x32x16_bf16 v[56:71], v[228:231], v[172:175], v[56:71]
    v_mfma_f32_32x32x16_bf16 v[72:87], v[232:235], v[168:171], v[72:87]
    v_mfma_f32_32x32x16_bf16 v[88:103], v[232:235], v[172:175], v[88:103]
    v_mfma_f32_32x32x16_bf16 v[104:119], v[236:239], v[168:171], v[104:119]
    v_mfma_f32_32x32x16_bf16 v[40:55], v[132:135], v[176:179], v[40:55]
    v_mfma_f32_32x32x16_bf16 v[56:71], v[132:135], v[180:183], v[56:71]
    v_mfma_f32_32x32x16_bf16 v[72:87], v[136:139], v[176:179], v[72:87]
    v_mfma_f32_32x32x16_bf16 v[88:103], v[136:139], v[180:183], v[88:103]
    v_mfma_f32_32x32x16_bf16 v[104:119], v[140:143], v[176:179], v[104:119]
    v_mfma_f32_32x32x16_bf16 v[40:55], v[120:123], v[184:187], v[40:55]
    v_mfma_f32_32x32x16_bf16 v[56:71], v[120:123], v[188:191], v[56:71]
    v_mfma_f32_32x32x16_bf16 v[72:87], v[124:127], v[184:187], v[72:87]
    v_mfma_f32_32x32x16_bf16 v[88:103], v[124:127], v[188:191], v[88:103]
    v_mfma_f32_32x32x16_bf16 v[104:119], v[128:131], v[184:187], v[104:119]
    v_sub_f32 v36, 1.0, v36
    v_sub_f32 v38, 1.0, v38
    s_nop 5
    v_pk_mul_f32 v[40:41], v[40:41], v[36:37] op_sel_hi:[1,0]
    v_pk_mul_f32 v[42:43], v[42:43], v[36:37] op_sel_hi:[1,0]
    v_pk_mul_f32 v[44:45], v[44:45], v[36:37] op_sel_hi:[1,0]
    v_pk_mul_f32 v[46:47], v[46:47], v[36:37] op_sel_hi:[1,0]
    v_pk_mul_f32 v[48:49], v[48:49], v[36:37] op_sel_hi:[1,0]
    v_pk_mul_f32 v[50:51], v[50:51], v[36:37] op_sel_hi:[1,0]
    v_pk_mul_f32 v[52:53], v[52:53], v[36:37] op_sel_hi:[1,0]
    v_pk_mul_f32 v[54:55], v[54:55], v[36:37] op_sel_hi:[1,0]
    v_pk_mul_f32 v[56:57], v[56:57], v[38:39] op_sel_hi:[1,0]
    v_pk_mul_f32 v[58:59], v[58:59], v[38:39] op_sel_hi:[1,0]
    v_pk_mul_f32 v[60:61], v[60:61], v[38:39] op_sel_hi:[1,0]
    v_pk_mul_f32 v[62:63], v[62:63], v[38:39] op_sel_hi:[1,0]
    v_pk_mul_f32 v[64:65], v[64:65], v[38:39] op_sel_hi:[1,0]
    v_pk_mul_f32 v[66:67], v[66:67], v[38:39] op_sel_hi:[1,0]
    v_pk_mul_f32 v[68:69], v[68:69], v[38:39] op_sel_hi:[1,0]
    v_pk_mul_f32 v[70:71], v[70:71], v[38:39] op_sel_hi:[1,0]
    v_pk_mul_f32 v[72:73], v[72:73], v[36:37] op_sel_hi:[1,0]
    v_pk_mul_f32 v[74:75], v[74:75], v[36:37] op_sel_hi:[1,0]
    v_pk_mul_f32 v[76:77], v[76:77], v[36:37] op_sel_hi:[1,0]
    v_pk_mul_f32 v[78:79], v[78:79], v[36:37] op_sel_hi:[1,0]
    v_pk_mul_f32 v[80:81], v[80:81], v[36:37] op_sel_hi:[1,0]
    v_pk_mul_f32 v[82:83], v[82:83], v[36:37] op_sel_hi:[1,0]
    v_pk_mul_f32 v[84:85], v[84:85], v[36:37] op_sel_hi:[1,0]
    v_pk_mul_f32 v[86:87], v[86:87], v[36:37] op_sel_hi:[1,0]
    v_pk_mul_f32 v[88:89], v[88:89], v[38:39] op_sel_hi:[1,0]
    v_pk_mul_f32 v[90:91], v[90:91], v[38:39] op_sel_hi:[1,0]
    v_pk_mul_f32 v[92:93], v[92:93], v[38:39] op_sel_hi:[1,0]
    v_pk_mul_f32 v[94:95], v[94:95], v[38:39] op_sel_hi:[1,0]
    v_pk_mul_f32 v[96:97], v[96:97], v[38:39] op_sel_hi:[1,0]
    v_pk_mul_f32 v[98:99], v[98:99], v[38:39] op_sel_hi:[1,0]
    v_pk_mul_f32 v[100:101], v[100:101], v[38:39] op_sel_hi:[1,0]
    v_pk_mul_f32 v[102:103], v[102:103], v[38:39] op_sel_hi:[1,0]
    v_pk_mul_f32 v[104:105], v[104:105], v[36:37] op_sel_hi:[1,0]
    v_pk_mul_f32 v[106:107], v[106:107], v[36:37] op_sel_hi:[1,0]
    v_pk_mul_f32 v[108:109], v[108:109], v[36:37] op_sel_hi:[1,0]
    v_pk_mul_f32 v[110:111], v[110:111], v[36:37] op_sel_hi:[1,0]
    v_pk_mul_f32 v[112:113], v[112:113], v[36:37] op_sel_hi:[1,0]
    v_pk_mul_f32 v[114:115], v[114:115], v[36:37] op_sel_hi:[1,0]
    v_pk_mul_f32 v[116:117], v[116:117], v[36:37] op_sel_hi:[1,0]
    v_pk_mul_f32 v[118:119], v[118:119], v[36:37] op_sel_hi:[1,0]
    s_mov_b32 s7, 400000
H_PROBE:
    buffer_load_dword v2, v3, s[20:23], s25 offen sc1
    s_mov_b32 s6, 0
    s_sub_u32 s7, s7, 1
    s_cmp_eq_u32 s7, 0
    s_cbranch_scc1 H_PROBE_OK
    s_waitcnt vmcnt(0)
    v_cmp_eq_u32 vcc, -1, v2
    s_nop 0
    s_and_b32 s5, vcc_lo, 255
    s_cbranch_scc0 H_PROBE_OK
    s_mov_b32 s6, 1
    s_and_b32 s5, vcc_lo, 255
    s_cbranch_scc0 H_PROBE_OK
    s_sleep 2
    s_branch H_PROBE
H_PROBE_OK:
    s_mov_b32 s6, 0
    s_lshl_b32 s5, s6, 12
    s_add_u32 s8, s24, s5
    s_add_u32 s9, s25, s5
    s_xor_b32 s5, s5, 4096
    s_add_u32 s10, s24, s5
    s_add_u32 s11, s25, s5
    s_lshl_b32 s5, s6, 10
    s_add_u32 s12, s28, s5
    s_add_u32 s13, s29, s5
    s_xor_b32 s5, s5, 1024
    s_add_u32 s14, s28, s5
    s_add_u32 s15, s29, s5
    buffer_load_dwordx4 v[160:163], v252, s[20:23], s8 offen offset:0 sc1
    buffer_load_dwordx4 v[164:167], v252, s[20:23], s9 offen offset:0 sc1
    buffer_load_dwordx4 v[168:171], v252, s[20:23], s8 offen offset:1024 sc1
    buffer_load_dwordx4 v[172:175], v252, s[20:23], s9 offen offset:1024 sc1
    buffer_load_dwordx4 v[176:179], v252, s[20:23], s8 offen offset:2048 sc1
    buffer_load_dwordx4 v[180:183], v252, s[20:23], s9 offen offset:2048 sc1
    buffer_load_dwordx4 v[184:187], v252, s[20:23], s8 offen offset:3072 sc1
    buffer_load_dwordx4 v[188:191], v252, s[20:23], s9 offen offset:3072 sc1
    buffer_load_dwordx2 v[192:193], v253, s[20:23], s12 offen offset:0 sc1
    buffer_load_dwordx2 v[194:195], v253, s[20:23], s12 offen offset:256 sc1
    buffer_load_dwordx2 v[196:197], v253, s[20:23], s13 offen offset:0 sc1
    buffer_load_dwordx2 v[198:199], v253, s[20:23], s13 offen offset:256 sc1
    buffer_load_dwordx4 v[200:203], v252, s[20:23], s10 offen offset:0 sc1
    buffer_load_dwordx4 v[204:207], v252, s[20:23], s11 offen offset:0 sc1
    buffer_load_dwordx4 v[208:211], v252, s[20:23], s10 offen offset:1024 sc1
    buffer_load_dwordx4 v[212:215], v252, s[20:23], s11 offen offset:1024 sc1
    buffer_load_dwordx4 v[216:219], v252, s[20:23], s10 offen offset:2048 sc1
    buffer_load_dwordx4 v[220:223], v252, s[20:23], s11 offen offset:2048 sc1
    buffer_load_dwordx4 v[224:227], v252, s[20:23], s10 offen offset:3072 sc1
    buffer_load_dwordx4 v[228:231], v252, s[20:23], s11 offen offset:3072 sc1
    buffer_load_dwordx2 v[232:233], v253, s[20:23], s14 offen offset:0 sc1
    buffer_load_dwordx2 v[234:235], v253, s[20:23], s14 offen offset:256 sc1
    buffer_load_dwordx2 v[236:237], v253, s[20:23], s15 offen offset:0 sc1
    buffer_load_dwordx2 v[238:239], v253, s[20:23], s15 offen offset:256 sc1
    s_mul_i32 s5, s6, 81920
    v_add_u32 v16, s5, v32
    v_add_u32 v17, s5, v12
    s_sub_u32 s5, 81920, s5
    v_add_u32 v18, s5, v32
    v_add_u32 v19, s5, v12
    s_mul_i32 s5, s6, 12288
    v_add_u32 v20, s5, v34
    v_add_u32 v21, s5, v14
    s_sub_u32 s5, 12288, s5
    v_add_u32 v22, s5, v34
    v_add_u32 v23, s5, v14
    s_lshl_b32 s6, s6, 2
    s_lshr_b32 s45, 0xf0, s6
    s_movk_i32 s7, 4000
    ds_read_b64_tr_b16 v[120:121], v16 offset:0
    ds_read_b64_tr_b16 v[122:123], v16 offset:1536
    ds_read_b64_tr_b16 v[124:125], v16 offset:64
    ds_read_b64_tr_b16 v[126:127], v16 offset:1600
    ds_read_b64_tr_b16 v[128:129], v17 offset:0
    ds_read_b64_tr_b16 v[130:131], v17 offset:1536
    ds_read_b64_tr_b16 v[132:133], v16 offset:12288
    ds_read_b64_tr_b16 v[134:135], v16 offset:13824
    ds_read_b64_tr_b16 v[136:137], v16 offset:12352
    ds_read_b64_tr_b16 v[138:139], v16 offset:13888
    ds_read_b64_tr_b16 v[140:141], v17 offset:12288
    ds_read_b64_tr_b16 v[142:143], v17 offset:13824
    s_waitcnt vmcnt(22)
H_CHK0:
    v_max3_u32 v2, v160, v161, v162
    v_max3_u32 v4, v163, v164, v165
    v_max3_u32 v2, v2, v166, v167
    v_max_u32 v2, v2, v4
    v_cmp_eq_u32 vcc, -1, v2
    s_nop 0
    s_cmp_lg_u64 vcc, 0
    s_cbranch_scc1 H_RETRY0
H_OK0:
    s_waitcnt lgkmcnt(6)
    v_mfma_f32_32x32x16_bf16 v[40:55], v[120:123], v[160:163], v[40:55]
    v_mfma_f32_32x32x16_bf16 v[56:71], v[120:123], v[164:167], v[56:71]
    ds_read_b64_tr_b16 v[120:121], v16 offset:24576
    ds_read_b64_tr_b16 v[122:123], v16 offset:26112
    v_mfma_f32_32x32x16_bf16 v[72:87], v[124:127], v[160:163], v[72:87]
    v_mfma_f32_32x32x16_bf16 v[88:103], v[124:127], v[164:167], v[88:103]
    ds_read_b64_tr_b16 v[124:125], v16 offset:24640
    ds_read_b64_tr_b16 v[126:127], v16 offset:26176
    s_waitcnt vmcnt(20)
H_CHK1:
    v_max3_u32 v2, v168, v169, v170
    v_max3_u32 v4, v171, v172, v173
    v_max3_u32 v2, v2, v174, v175
    v_max_u32 v2, v2, v4
    v_cmp_eq_u32 vcc, -1, v2
    s_nop 0
    s_cmp_lg_u64 vcc, 0
    s_cbranch_scc1 H_RETRY1
H_OK1:
    v_mfma_f32_32x32x16_bf16 v[104:119], v[128:131], v[160:163], v[104:119]
    ds_read_b64_tr_b16 v[128:129], v17 offset:24576
    ds_read_b64_tr_b16 v[130:131], v17 offset:26112
    s_waitcnt lgkmcnt(6)
    v_mfma_f32_32x32x16_bf16 v[40:55], v[132:135], v[168:171], v[40:55]
    v_mfma_f32_32x32x16_bf16 v[56:71], v[132:135], v[172:175], v[56:71]
    ds_read_b64_tr_b16 v[132:133], v16 offset:36864
    ds_read_b64_tr_b16 v[134:135], v16 offset:38400
    v_mfma_f32_32x32x16_bf16 v[72:87], v[136:139], v[168:171], v[72:87]
    v_mfma_f32_32x32x16_bf16 v[88:103], v[136:139], v[172:175], v[88:103]
    ds_read_b64_tr_b16 v[136:137], v16 offset:36928
    ds_read_b64_tr_b16 v[138:139], v16 offset:38464
    s_waitcnt vmcnt(18)
H_CHK2:
    v_max3_u32 v2, v176, v177, v178
    v_max3_u32 v4, v179, v180, v181
    v_max3_u32 v2, v2, v182, v183
    v_max_u32 v2, v2, v4
    v_cmp_eq_u32 vcc, -1, v2
    s_nop 0
    s_cmp_lg_u64 vcc, 0
    s_cbranch_scc1 H_RETRY2
H_OK2:
    v_mfma_f32_32x32x16_bf16 v[104:119], v[140:143], v[168:171], v[104:119]
    ds_read_b64_tr_b16 v[140:141], v17 offset:36864
    ds_read_b64_tr_b16 v[142:143], v17 offset:38400
    s_waitcnt lgkmcnt(6)
    v_mfma_f32_32x32x16_bf16 v[40:55], v[120:123], v[176:179], v[40:55]
    v_mfma_f32_32x32x16_bf16 v[56:71], v[120:123], v[180:183], v[56:71]
    ds_read_b64_tr_b16 v[120:121], v20 offset:0
    ds_read_b64_tr_b16 v[122:123], v20 offset:1536
    v_mfma_f32_32x32x16_bf16 v[72:87], v[124:127], v[176:179], v[72:87]
    v_mfma_f32_32x32x16_bf16 v[88:103], v[124:127], v[180:183], v[88:103]
    ds_read_b64_tr_b16 v[124:125], v20 offset:64
    ds_read_b64_tr_b16 v[126:127], v20 offset:1600
    s_waitcnt vmcnt(16)
H_CHK3:
    v_max3_u32 v2, v184, v185, v186
    v_max3_u32 v4, v187, v188, v189
    v_max3_u32 v2, v2, v190, v191
    v_max_u32 v2, v2, v4
    v_cmp_eq_u32 vcc, -1, v2
    s_nop 0
    s_cmp_lg_u64 vcc, 0
    s_cbranch_scc1 H_RETRY3
H_OK3:
    v_mfma_f32_32x32x16_bf16 v[104:119], v[128:131], v[176:179], v[104:119]
    ds_read_b64_tr_b16 v[128:129], v21 offset:0
    ds_read_b64_tr_b16 v[130:131], v21 offset:1536
    s_waitcnt lgkmcnt(6)
    v_mfma_f32_32x32x16_bf16 v[40:55], v[132:135], v[184:187], v[40:55]
    v_mfma_f32_32x32x16_bf16 v[56:71], v[132:135], v[188:191], v[56:71]
    ds_read_b64_tr_b16 v[132:133], v18 offset:0
    ds_read_b64_tr_b16 v[134:135], v18 offset:1536
    v_mfma_f32_32x32x16_bf16 v[72:87], v[136:139], v[184:187], v[72:87]
    v_mfma_f32_32x32x16_bf16 v[88:103], v[136:139], v[188:191], v[88:103]
    ds_read_b64_tr_b16 v[136:137], v18 offset:64
    ds_read_b64_tr_b16 v[138:139], v18 offset:1600
    s_waitcnt vmcnt(12)
H_CHK4:
    v_max3_u32 v2, v192, v193, v194
    v_max3_u32 v4, v195, v196, v197
    v_max3_u32 v2, v2, v198, v199
    v_max_u32 v2, v2, v4
    v_cmp_eq_u32 vcc, -1, v2
    s_nop 0
    s_cmp_lg_u64 vcc, 0
    s_cbranch_scc1 H_RETRY4
H_OK4:
    v_mfma_f32_32x32x16_bf16 v[104:119], v[140:143], v[184:187], v[104:119]
    ds_read_b64_tr_b16 v[140:141], v19 offset:0
    ds_read_b64_tr_b16 v[142:143], v19 offset:1536
    s_waitcnt lgkmcnt(6)
    v_mfma_f32_32x32x16_bf16 v[40:55], v[120:123], v[192:195], v[40:55]
    v_mfma_f32_32x32x16_bf16 v[56:71], v[120:123], v[196:199], v[56:71]
    ds_read_b64_tr_b16 v[120:121], v18 offset:12288
    ds_read_b64_tr_b16 v[122:123], v18 offset:13824
    v_mfma_f32_32x32x16_bf16 v[72:87], v[124:127], v[192:195], v[72:87]
    v_mfma_f32_32x32x16_bf16 v[88:103], v[124:127], v[196:199], v[88:103]
    ds_read_b64_tr_b16 v[124:125], v18 offset:12352
    ds_read_b64_tr_b16 v[126:127], v18 offset:13888
    v_mfma_f32_32x32x16_bf16 v[104:119], v[128:131], v[192:195], v[104:119]
    ds_read_b64_tr_b16 v[128:129], v19 offset:12288
    ds_read_b64_tr_b16 v[130:131], v19 offset:13824
H_W5:
    s_waitcnt vmcnt(10)
H_CHK5:
    v_max3_u32 v2, v200, v201, v202
    v_max3_u32 v4, v203, v204, v205
    v_max3_u32 v2, v2, v206, v207
    v_max_u32 v2, v2, v4
    v_cmp_eq_u32 vcc, -1, v2
    s_nop 0
    s_cmp_lg_u64 vcc, 0
    s_cbranch_scc1 H_RETRY5
H_OK5:
    s_waitcnt lgkmcnt(6)
    v_mfma_f32_32x32x16_bf16 v[40:55], v[132:135], v[200:203], v[40:55]
    v_mfma_f32_32x32x16_bf16 v[56:71], v[132:135], v[204:207], v[56:71]
    ds_read_b64_tr_b16 v[132:133], v18 offset:24576
    ds_read_b64_tr_b16 v[134:135], v18 offset:26112
    v_mfma_f32_32x32x16_bf16 v[72:87], v[136:139], v[200:203], v[72:87]
    v_mfma_f32_32x32x16_bf16 v[88:103], v[136:139], v[204:207], v[88:103]
    ds_read_b64_tr_b16 v[136:137], v18 offset:24640
    ds_read_b64_tr_b16 v[138:139], v18 offset:26176
    s_waitcnt vmcnt(8)
H_CHK6:
    v_max3_u32 v2, v208, v209, v210
    v_max3_u32 v4, v211, v212, v213
    v_max3_u32 v2, v2, v214, v215
    v_max_u32 v2, v2, v4
    v_cmp_eq_u32 vcc, -1, v2
    s_nop 0
    s_cmp_lg_u64 vcc, 0
    s_cbranch_scc1 H_RETRY6
H_OK6:
    v_mfma_f32_32x32x16_bf16 v[104:119], v[140:143], v[200:203], v[104:119]
    ds_read_b64_tr_b16 v[140:141], v19 offset:24576
    ds_read_b64_tr_b16 v[142:143], v19 offset:26112
    s_waitcnt lgkmcnt(6)
    v_mfma_f32_32x32x16_bf16 v[40:55], v[120:123], v[208:211], v[40:55]
    v_mfma_f32_32x32x16_bf16 v[56:71], v[120:123], v[212:215], v[56:71]
    ds_read_b64_tr_b16 v[120:121], v18 offset:36864
    ds_read_b64_tr_b16 v[122:123], v18 offset:38400
    v_mfma_f32_32x32x16_bf16 v[72:87], v[124:127], v[208:211], v[72:87]
    v_mfma_f32_32x32x16_bf16 v[88:103], v[124:127], v[212:215], v[88:103]
    ds_read_b64_tr_b16 v[124:125], v18 offset:36928
    ds_read_b64_tr_b16 v[126:127], v18 offset:38464
    s_waitcnt vmcnt(6)
H_CHK7:
    v_max3_u32 v2, v216, v217, v218
    v_max3_u32 v4, v219, v220, v221
    v_max3_u32 v2, v2, v222, v223
    v_max_u32 v2, v2, v4
    v_cmp_eq_u32 vcc, -1, v2
    s_nop 0
    s_cmp_lg_u64 vcc, 0
    s_cbranch_scc1 H_RETRY7
H_OK7:
    v_mfma_f32_32x32x16_bf16 v[104:119], v[128:131], v[208:211], v[104:119]
    ds_read_b64_tr_b16 v[128:129], v19 offset:36864
    ds_read_b64_tr_b16 v[130:131], v19 offset:38400
    s_waitcnt lgkmcnt(6)
    v_mfma_f32_32x32x16_bf16 v[40:55], v[132:135], v[216:219], v[40:55]
    v_mfma_f32_32x32x16_bf16 v[56:71], v[132:135], v[220:223], v[56:71]
    ds_read_b64_tr_b16 v[132:133], v22 offset:0
    ds_read_b64_tr_b16 v[134:135], v22 offset:1536
    v_mfma_f32_32x32x16_bf16 v[72:87], v[136:139], v[216:219], v[72:87]
    v_mfma_f32_32x32x16_bf16 v[88:103], v[136:139], v[220:223], v[88:103]
    ds_read_b64_tr_b16 v[136:137], v22 offset:64
    ds_read_b64_tr_b16 v[138:139], v22 offset:1600
    s_waitcnt vmcnt(4)
H_CHK8:
    v_max3_u32 v2, v224, v225, v226
    v_max3_u32 v4, v227, v228, v229
    v_max3_u32 v2, v2, v230, v231
    v_max_u32 v2, v2, v4
    v_cmp_eq_u32 vcc, -1, v2
    s_nop 0
    s_cmp_lg_u64 vcc, 0
    s_cbranch_scc1 H_RETRY8
H_OK8:
    v_mfma_f32_32x32x16_bf16 v[104:119], v[140:143], v[216:219], v[104:119]
    ds_read_b64_tr_b16 v[140:141], v23 offset:0
    ds_read_b64_tr_b16 v[142:143], v23 offset:1536
    s_waitcnt lgkmcnt(6)
    v_mfma_f32_32x32x16_bf16 v[40:55], v[120:123], v[224:227], v[40:55]
    v_mfma_f32_32x32x16_bf16 v[56:71], v[120:123], v[228:231], v[56:71]
    v_mfma_f32_32x32x16_bf16 v[72:87], v[124:127], v[224:227], v[72:87]
    v_mfma_f32_32x32x16_bf16 v[88:103], v[124:127], v[228:231], v[88:103]
    s_waitcnt vmcnt(0)
H_CHK9:
    v_max3_u32 v2, v232, v233, v234
    v_max3_u32 v4, v235, v236, v237
    v_max3_u32 v2, v2, v238, v239
    v_max_u32 v2, v2, v4
    v_cmp_eq_u32 vcc, -1, v2
    s_nop 0
    s_cmp_lg_u64 vcc, 0
    s_cbranch_scc1 H_RETRY9
H_OK9:
    v_mfma_f32_32x32x16_bf16 v[104:119], v[128:131], v[224:227], v[104:119]
    s_waitcnt lgkmcnt(0)
    v_mfma_f32_32x32x16_bf16 v[40:55], v[132:135], v[232:235], v[40:55]
    v_mfma_f32_32x32x16_bf16 v[56:71], v[132:135], v[236:239], v[56:71]
    v_mfma_f32_32x32x16_bf16 v[72:87], v[136:139], v[232:235], v[72:87]
    v_mfma_f32_32x32x16_bf16 v[88:103], v[136:139], v[236:239], v[88:103]
    v_mfma_f32_32x32x16_bf16 v[104:119], v[140:143], v[232:235], v[104:119]
    s_nop 7
    ds_write_b128 v24, v[40:43] offset:0
    ds_write_b128 v24, v[44:47] offset:32
    ds_write_b128 v24, v[48:51] offset:64
    ds_write_b128 v24, v[52:55] offset:96
    ds_write_b128 v24, v[56:59] offset:24576
    ds_write_b128 v24, v[60:63] offset:24608
    ds_write_b128 v24, v[64:67] offset:24640
    ds_write_b128 v24, v[68:71] offset:24672
    ds_write_b128 v25, v[72:75] offset:0
    ds_write_b128 v25, v[76:79] offset:32
    ds_write_b128 v25, v[80:83] offset:64
    ds_write_b128 v25, v[84:87] offset:96
    ds_write_b128 v25, v[88:91] offset:24576
    ds_write_b128 v25, v[92:95] offset:24608
    ds_write_b128 v25, v[96:99] offset:24640
    ds_write_b128 v25, v[100:103] offset:24672
    ds_write_b128 v25, v[104:107] offset:49152
    ds_write_b128 v25, v[108:111] offset:49184
    ds_write_b128 v25, v[112:115] offset:49216
    ds_write_b128 v25, v[116:119] offset:49248
    s_waitcnt lgkmcnt(0)
    s_barrier
    ds_read_b128 v[144:147], v26 offset:0
    ds_read_b128 v[148:151], v26 offset:16
    ds_read_b128 v[152:155], v26 offset:3072
    ds_read_b128 v[156:159], v26 offset:3088
    ds_read_b128 v[160:163], v26 offset:6144
    ds_read_b128 v[164:167], v26 offset:6160
    ds_read_b128 v[168:171], v26 offset:9216
    ds_read_b128 v[172:175], v26 offset:9232
    ds_read_b128 v[176:179], v27 offset:0
    ds_read_b128 v[180:183], v27 offset:16
    ds_read_b128 v[184:187], v27 offset:3072
    ds_read_b128 v[188:191], v27 offset:3088
    ds_read_b128 v[192:195], v27 offset:6144
    ds_read_b128 v[196:199], v27 offset:6160
    ds_read_b128 v[200:203], v27 offset:9216
    ds_read_b128 v[204:207], v27 offset:9232
    s_waitcnt lgkmcnt(8)
    s_cmp_lt_u32 s58, 2
    s_cbranch_scc0 H_RED2
    ds_read_b128 v[208:211], v29 offset:0
    ds_read_b128 v[212:215], v29 offset:16
    ds_read_b128 v[216:219], v29 offset:3072
    ds_read_b128 v[220:223], v29 offset:3088
    ds_read_b128 v[224:227], v29 offset:6144
    ds_read_b128 v[228:231], v29 offset:6160
    ds_read_b128 v[232:235], v29 offset:9216
    ds_read_b128 v[236:239], v29 offset:9232
    v_pk_add_f32 v[144:145], v[144:145], v[152:153]
    v_pk_add_f32 v[160:161], v[160:161], v[168:169]
    v_pk_add_f32 v[146:147], v[146:147], v[154:155]
    v_pk_add_f32 v[162:163], v[162:163], v[170:171]
    v_pk_add_f32 v[148:149], v[148:149], v[156:157]
    v_pk_add_f32 v[164:165], v[164:165], v[172:173]
    v_pk_add_f32 v[150:151], v[150:151], v[158:159]
    v_pk_add_f32 v[166:167], v[166:167], v[174:175]
    v_pk_add_f32 v[144:145], v[144:145], v[160:161]
    v_pk_add_f32 v[146:147], v[146:147], v[162:163]
    v_pk_add_f32 v[148:149], v[148:149], v[164:165]
    v_pk_add_f32 v[150:151], v[150:151], v[166:167]
    v_cvt_pk_bf16_f32 v144, v144, v145
    v_cvt_pk_bf16_f32 v145, v146, v147
    v_cvt_pk_bf16_f32 v146, v148, v149
    v_cvt_pk_bf16_f32 v147, v150, v151
    buffer_store_dwordx4 v[144:147], v28, s[40:43], s16 offen sc1
    s_waitcnt lgkmcnt(8)
    v_pk_add_f32 v[176:177], v[176:177], v[184:185]
    v_pk_add_f32 v[192:193], v[192:193], v[200:201]
    v_pk_add_f32 v[178:179], v[178:179], v[186:187]
    v_pk_add_f32 v[194:195], v[194:195], v[202:203]
    v_pk_add_f32 v[180:181], v[180:181], v[188:189]
    v_pk_add_f32 v[196:197], v[196:197], v[204:205]
    v_pk_add_f32 v[182:183], v[182:183], v[190:191]
    v_pk_add_f32 v[198:199], v[198:199], v[206:207]
    v_pk_add_f32 v[176:177], v[176:177], v[192:193]
    v_pk_add_f32 v[178:179], v[178:179], v[194:195]
    v_pk_add_f32 v[180:181], v[180:181], v[196:197]
    v_pk_add_f32 v[182:183], v[182:183], v[198:199]
    v_cvt_pk_bf16_f32 v176, v176, v177
    v_cvt_pk_bf16_f32 v177, v178, v179
    v_cvt_pk_bf16_f32 v178, v180, v181
    v_cvt_pk_bf16_f32 v179, v182, v183
    buffer_store_dwordx4 v[176:179], v28, s[40:43], s17 offen sc1
    s_waitcnt lgkmcnt(0)
    v_pk_add_f32 v[208:209], v[208:209], v[216:217]
    v_pk_add_f32 v[224:225], v[224:225], v[232:233]
    v_pk_add_f32 v[210:211], v[210:211], v[218:219]
    v_pk_add_f32 v[226:227], v[226:227], v[234:235]
    v_pk_add_f32 v[212:213], v[212:213], v[220:221]
    v_pk_add_f32 v[228:229], v[228:229], v[236:237]
    v_pk_add_f32 v[214:215], v[214:215], v[222:223]
    v_pk_add_f32 v[230:231], v[230:231], v[238:239]
    v_pk_add_f32 v[208:209], v[208:209], v[224:225]
    v_pk_add_f32 v[210:211], v[210:211], v[226:227]
    v_pk_add_f32 v[212:213], v[212:213], v[228:229]
    v_pk_add_f32 v[214:215], v[214:215], v[230:231]
    v_cvt_pk_bf16_f32 v208, v208, v209
    v_cvt_pk_bf16_f32 v209, v210, v211
    v_cvt_pk_bf16_f32 v210, v212, v213
    v_cvt_pk_bf16_f32 v211, v214, v215
    buffer_store_dwordx4 v[208:211], v28, s[40:43], s18 offen sc1
    s_branch H_RED3
H_RED2:
    v_pk_add_f32 v[144:145], v[144:145], v[152:153]
    v_pk_add_f32 v[160:161], v[160:161], v[168:169]
    v_pk_add_f32 v[146:147], v[146:147], v[154:155]
    v_pk_add_f32 v[162:163], v[162:163], v[170:171]
    v_pk_add_f32 v[148:149], v[148:149], v[156:157]
    v_pk_add_f32 v[164:165], v[164:165], v[172:173]
    v_pk_add_f32 v[150:151], v[150:151], v[158:159]
    v_pk_add_f32 v[166:167], v[166:167], v[174:175]
    v_pk_add_f32 v[144:145], v[144:145], v[160:161]
    v_pk_add_f32 v[146:147], v[146:147], v[162:163]
    v_pk_add_f32 v[148:149], v[148:149], v[164:165]
    v_pk_add_f32 v[150:151], v[150:151], v[166:167]
    v_cvt_pk_bf16_f32 v144, v144, v145
    v_cvt_pk_bf16_f32 v145, v146, v147
    v_cvt_pk_bf16_f32 v146, v148, v149
    v_cvt_pk_bf16_f32 v147, v150, v151
    buffer_store_dwordx4 v[144:147], v28, s[40:43], s16 offen sc1
    s_waitcnt lgkmcnt(0)
    v_pk_add_f32 v[176:177], v[176:177], v[184:185]
    v_pk_add_f32 v[192:193], v[192:193], v[200:201]
    v_pk_add_f32 v[178:179], v[178:179], v[186:187]
    v_pk_add_f32 v[194:195], v[194:195], v[202:203]
    v_pk_add_f32 v[180:181], v[180:181], v[188:189]
    v_pk_add_f32 v[196:197], v[196:197], v[204:205]
    v_pk_add_f32 v[182:183], v[182:183], v[190:191]
    v_pk_add_f32 v[198:199], v[198:199], v[206:207]
    v_pk_add_f32 v[176:177], v[176:177], v[192:193]
    v_pk_add_f32 v[178:179], v[178:179], v[194:195]
    v_pk_add_f32 v[180:181], v[180:181], v[196:197]
    v_pk_add_f32 v[182:183], v[182:183], v[198:199]
    v_cvt_pk_bf16_f32 v176, v176, v177
    v_cvt_pk_bf16_f32 v177, v178, v179
    v_cvt_pk_bf16_f32 v178, v180, v181
    v_cvt_pk_bf16_f32 v179, v182, v183
    buffer_store_dwordx4 v[176:179], v28, s[40:43], s17 offen sc1
H_RED3:
    s_branch L_END
H_GATE:
    v_and_b32 v5, 1, v3
    v_cmp_eq_u32 vcc, v5, v4
    v_lshlrev_b32 v2, 1, v2
    v_and_b32 v2, -4, v2
    v_add_u32 v2, 4096, v2
    v_mov_b32 v5, 0x7f000000
    v_cndmask_b32 v20, v5, v2, vcc
    s_movk_i32 s60, 128
    s_movk_i32 s7, -1016
    s_sub_u32 s12, s28, 4096
    s_subb_u32 s13, s29, 0
    s_movk_i32 s14, 5376
    s_branch H_GATEBACK
H_POLLA2_SLOW:
    s_mov_b32 s5, 21037056
    s_mov_b32 s7, 400000
H_POLLA2:
    buffer_load_dwordx2 v[6:7], v255, s[20:23], s5 offen sc1
    s_waitcnt vmcnt(0)
    s_setprio 2
    v_xor_b32 v6, s55, v6
    v_xor_b32 v7, s55, v7
    v_or3_b32 v6, v6, v7, v7
    v_cmp_ne_u32 vcc, 0, v6
    s_setprio 0
    s_cmp_eq_u64 vcc, 0
    s_cbranch_scc1 H_POLLA2_OK
    s_sub_u32 s7, s7, 1
    s_cmp_eq_u32 s7, 0
    s_cbranch_scc1 H_POLLA2_OK
    s_sleep 2
    s_branch H_POLLA2
H_POLLA2_OK:
    s_branch H_POLLA2_BACK
H_POLLP_SLOW:
    s_lshl_b32 s5, s52, 7
    s_lshl_b32 s6, s58, 5
    s_add_u32 s5, s5, s6
    s_add_u32 s5, s5, 21102592
    s_mov_b32 s7, 400000
H_POLLP:
    buffer_load_dword v6, v3, s[20:23], s5 offen sc1
    s_waitcnt vmcnt(0)
    s_setprio 2
    v_xor_b32 v6, s55, v6
    v_cmp_ne_u32 vcc, 0, v6
    s_setprio 0
    s_cmp_eq_u64 vcc, 0
    s_cbranch_scc1 H_POLLP_OK
    s_sub_u32 s7, s7, 1
    s_cmp_eq_u32 s7, 0
    s_cbranch_scc1 H_POLLP_OK
    s_sleep 2
    s_branch H_POLLP
H_POLLP_OK:
    s_branch H_POLLP_BACK
H_RETRY0:
    s_sub_u32 s7, s7, 1
    s_cmp_lt_i32 s7, 0
    s_cbranch_scc1 H_OK0
    buffer_load_dwordx4 v[160:163], v252, s[20:23], s8 offen offset:0 sc1
    buffer_load_dwordx4 v[164:167], v252, s[20:23], s9 offen offset:0 sc1
    s_waitcnt vmcnt(0)
    s_branch H_CHK0
H_RETRY1:
    s_sub_u32 s7, s7, 1
    s_cmp_lt_i32 s7, 0
    s_cbranch_scc1 H_OK1
    buffer_load_dwordx4 v[168:171], v252, s[20:23], s8 offen offset:1024 sc1
    buffer_load_dwordx4 v[172:175], v252, s[20:23], s9 offen offset:1024 sc1
    s_waitcnt vmcnt(0)
    s_branch H_CHK1
H_RETRY2:
    s_sub_u32 s7, s7, 1
    s_cmp_lt_i32 s7, 0
    s_cbranch_scc1 H_OK2
    buffer_load_dwordx4 v[176:179], v252, s[20:23], s8 offen offset:2048 sc1
    buffer_load_dwordx4 v[180:183], v252, s[20:23], s9 offen offset:2048 sc1
    s_waitcnt vmcnt(0)
    s_branch H_CHK2
H_RETRY3:
    s_sub_u32 s7, s7, 1
    s_cmp_lt_i32 s7, 0
    s_cbranch_scc1 H_OK3
    buffer_load_dwordx4 v[184:187], v252, s[20:23], s8 offen offset:3072 sc1
    buffer_load_dwordx4 v[188:191], v252, s[20:23], s9 offen offset:3072 sc1
    s_waitcnt vmcnt(0)
    s_branch H_CHK3
H_RETRY4:
    s_sub_u32 s7, s7, 1
    s_cmp_lt_i32 s7, 0
    s_cbranch_scc1 H_OK4
    buffer_load_dwordx2 v[192:193], v253, s[20:23], s12 offen offset:0 sc1
    buffer_load_dwordx2 v[194:195], v253, s[20:23], s12 offen offset:256 sc1
    buffer_load_dwordx2 v[196:197], v253, s[20:23], s13 offen offset:0 sc1
    buffer_load_dwordx2 v[198:199], v253, s[20:23], s13 offen offset:256 sc1
    s_waitcnt vmcnt(0)
    s_branch H_CHK4
H_RETRY5:
    s_sub_u32 s7, s7, 1
    s_cmp_lt_i32 s7, 0
    s_cbranch_scc1 H_OK5
    s_mov_b32 s6, 400000
H_PROBE2:
    buffer_load_dword v2, v3, s[20:23], s25 offen sc1
    s_sub_u32 s6, s6, 1
    s_cmp_eq_u32 s6, 0
    s_cbranch_scc1 H_PROBE2_OK
    s_waitcnt vmcnt(0)
    v_cmp_eq_u32 vcc, -1, v2
    s_nop 0
    s_and_b32 s5, vcc_lo, s45
    s_cbranch_scc0 H_PROBE2_OK
    s_sleep 2
    s_branch H_PROBE2
H_PROBE2_OK:
    buffer_load_dwordx4 v[200:203], v252, s[20:23], s10 offen offset:0 sc1
    buffer_load_dwordx4 v[204:207], v252, s[20:23], s11 offen offset:0 sc1
    buffer_load_dwordx4 v[208:211], v252, s[20:23], s10 offen offset:1024 sc1
    buffer_load_dwordx4 v[212:215], v252, s[20:23], s11 offen offset:1024 sc1
    buffer_load_dwordx4 v[216:219], v252, s[20:23], s10 offen offset:2048 sc1
    buffer_load_dwordx4 v[220:223], v252, s[20:23], s11 offen offset:2048 sc1
    buffer_load_dwordx4 v[224:227], v252, s[20:23], s10 offen offset:3072 sc1
    buffer_load_dwordx4 v[228:231], v252, s[20:23], s11 offen offset:3072 sc1
    buffer_load_dwordx2 v[232:233], v253, s[20:23], s14 offen offset:0 sc1
    buffer_load_dwordx2 v[234:235], v253, s[20:23], s14 offen offset:256 sc1
    buffer_load_dwordx2 v[236:237], v253, s[20:23], s15 offen offset:0 sc1
    buffer_load_dwordx2 v[238:239], v253, s[20:23], s15 offen offset:256 sc1
    s_branch H_W5
H_RETRY6:
    s_sub_u32 s7, s7, 1
    s_cmp_lt_i32 s7, 0
    s_cbranch_scc1 H_OK6
    buffer_load_dwordx4 v[208:211], v252, s[20:23], s10 offen offset:1024 sc1
    buffer_load_dwordx4 v[212:215], v252, s[20:23], s11 offen offset:1024 sc1
    s_waitcnt vmcnt(0)
    s_branch H_CHK6
H_RETRY7:
    s_sub_u32 s7, s7, 1
    s_cmp_lt_i32 s7, 0
    s_cbranch_scc1 H_OK7
    buffer_load_dwordx4 v[216:219], v252, s[20:23], s10 offen offset:2048 sc1
    buffer_load_dwordx4 v[220:223], v252, s[20:23], s11 offen offset:2048 sc1
    s_waitcnt vmcnt(0)
    s_branch H_CHK7
H_RETRY8:
    s_sub_u32 s7, s7, 1
    s_cmp_lt_i32 s7, 0
    s_cbranch_scc1 H_OK8
    buffer_load_dwordx4 v[224:227], v252, s[20:23], s10 offen offset:3072 sc1
    buffer_load_dwordx4 v[228:231], v252, s[20:23], s11 offen offset:3072 sc1
    s_waitcnt vmcnt(0)
    s_branch H_CHK8
H_RETRY9:
    s_sub_u32 s7, s7, 1
    s_cmp_lt_i32 s7, 0
    s_cbranch_scc1 H_OK9
    buffer_load_dwordx2 v[232:233], v253, s[20:23], s14 offen offset:0 sc1
    buffer_load_dwordx2 v[234:235], v253, s[20:23], s14 offen offset:256 sc1
    buffer_load_dwordx2 v[236:237], v253, s[20:23], s15 offen offset:0 sc1
    buffer_load_dwordx2 v[238:239], v253, s[20:23], s15 offen offset:256 sc1
    s_waitcnt vmcnt(0)
    s_branch H_CHK9
L_MAIN:
    s_mov_b32 s18, 1966080
    s_mov_b32 s19, 0x00020000
    s_mov_b32 s22, 22020096
    s_mov_b32 s23, 0x00020000
    s_mov_b32 s46, 256
    s_mov_b32 s47, 0x00020000
    s_mov_b32 s42, 2621440
    s_mov_b32 s43, 0x00020000
    s_or_b32 s5, s2, s4
    s_cmp_eq_u32 s5, 0
    s_cbranch_scc0 M_NONONCE
    s_memrealtime s[56:57]
    s_waitcnt lgkmcnt(0)
    s_or_b32 s56, s56, 1
    v_mov_b32 v9, s56
    v_mov_b32 v8, 0
    s_mov_b64 exec, 1
    buffer_store_dword v9, v8, s[44:47], 0 offen sc1
    s_mov_b64 exec, -1
M_NONONCE:
    s_cmp_eq_u32 s4, 1
    s_cbranch_scc0 M_NOPF
    v_subrev_u32 v254, 0, v0
    v_cmp_gt_u32 vcc, 10, v254
    s_lshr_b32 s5, s2, 3
    s_mul_i32 s5, s5, 1280
    v_lshl_add_u32 v254, v254, 7, s5
    v_min_u32 v254, L_EXIT-gated_mix__mha_block__dense_activation_mish__prompt_kernel, v254
    s_getpc_b64 s[56:57]
L_PC:
    s_sub_u32 s56, s56, L_PC-gated_mix__mha_block__dense_activation_mish__prompt_kernel
    s_subb_u32 s57, s57, 0
    s_and_saveexec_b64 s[6:7], vcc
    s_cbranch_execz L_NOPF
    global_load_dword v255, v254, s[56:57]
L_NOPF:
    s_mov_b64 exec, s[6:7]
M_NOPF:
    v_and_b32 v1, 31, v0
    v_lshrrev_b32 v2, 5, v0
    v_lshrrev_b32 v3, 1, v1
    v_and_b32 v3, 7, v3
    v_xor_b32 v3, v3, v2
    s_lshl_b32 s5, s4, 12
    v_lshlrev_b32 v4, 7, v1
    v_add_u32 v4, s5, v4
    v_xor_b32 v32, 0, v3
    v_lshl_add_u32 v16, v32, 4, v4
    v_xor_b32 v32, 2, v3
    v_lshl_add_u32 v17, v32, 4, v4
    v_xor_b32 v32, 4, v3
    v_lshl_add_u32 v18, v32, 4, v4
    v_xor_b32 v32, 6, v3
    v_lshl_add_u32 v19, v32, 4, v4
    v_bfe_u32 v32, v0, 4, 1
    v_bfe_u32 v33, v0, 2, 2
    v_bfe_u32 v34, v0, 0, 1
    v_bfe_u32 v35, v0, 1, 1
    s_sub_u32 s5, s49, 10
    s_cmp_lt_u32 s5, 5
    s_cselect_b32 s58, 1, 0
    s_cselect_b64 vcc, -1, 0
    v_lshl_add_u32 v36, v2, 3, v33
    v_cndmask_b32 v37, v34, v35, vcc
    v_cndmask_b32 v38, v35, v34, vcc
    v_lshl_add_u32 v37, v32, 1, v37
    v_lshl_add_u32 v37, v33, 2, v37
    v_lshlrev_b32 v39, 8, v36
    v_lshl_add_u32 v39, v38, 3, v39
    v_add_u32 v39, 65536, v39
    v_add_u32 v40, 0, v37
    v_and_b32 v40, 15, v40
    v_lshl_add_u32 v20, v40, 4, v39
    v_add_u32 v40, 4, v37
    v_and_b32 v40, 15, v40
    v_lshl_add_u32 v21, v40, 4, v39
    v_add_u32 v40, 8, v37
    v_and_b32 v40, 15, v40
    v_lshl_add_u32 v22, v40, 4, v39
    v_add_u32 v40, 12, v37
    v_and_b32 v40, 15, v40
    v_lshl_add_u32 v23, v40, 4, v39
    v_mul_u32_u24 v3, 192, v36
    v_lshl_add_u32 v3, v32, 5, v3
    v_and_b32 v40, 3, v0
    v_lshl_add_u32 v3, v40, 3, v3
    s_lshl_b32 s59, s48, 2
    s_add_u32 s59, s59, s4
    s_cmp_eq_u32 s58, 1
    s_cbranch_scc1 M_AV
    s_lshl_b32 s5, s49, 4
    s_mov_b32 s6, 0x40840
    s_mov_b32 s7, 163840
    v_add_u32 v32, 0, v2
    v_add_u32 v32, s5, v32
    v_mul_u32_u24 v33, 205, v32
    v_lshrrev_b32 v33, 10, v33
    v_mul_u32_u24 v34, 5, v33
    v_sub_u32 v34, v32, v34
    v_lshlrev_b32 v35, 2, v34
    v_lshrrev_b32 v35, v35, s6
    v_and_b32 v35, 15, v35
    v_xor_b32 v35, v35, v1
    v_mul_lo_u32 v33, v33, s7
    v_lshl_add_u32 v33, v34, 9, v33
    v_lshl_add_u32 v8, v35, 4, v33
    v_add_u32 v32, 2, v2
    v_add_u32 v32, s5, v32
    v_mul_u32_u24 v33, 205, v32
    v_lshrrev_b32 v33, 10, v33
    v_mul_u32_u24 v34, 5, v33
    v_sub_u32 v34, v32, v34
    v_lshlrev_b32 v35, 2, v34
    v_lshrrev_b32 v35, v35, s6
    v_and_b32 v35, 15, v35
    v_xor_b32 v35, v35, v1
    v_mul_lo_u32 v33, v33, s7
    v_lshl_add_u32 v33, v34, 9, v33
    v_lshl_add_u32 v9, v35, 4, v33
    v_add_u32 v32, 4, v2
    v_add_u32 v32, s5, v32
    v_mul_u32_u24 v33, 205, v32
    v_lshrrev_b32 v33, 10, v33
    v_mul_u32_u24 v34, 5, v33
    v_sub_u32 v34, v32, v34
    v_lshlrev_b32 v35, 2, v34
    v_lshrrev_b32 v35, v35, s6
    v_and_b32 v35, 15, v35
    v_xor_b32 v35, v35, v1
    v_mul_lo_u32 v33, v33, s7
    v_lshl_add_u32 v33, v34, 9, v33
    v_lshl_add_u32 v10, v35, 4, v33
    v_add_u32 v32, 6, v2
    v_add_u32 v32, s5, v32
    v_mul_u32_u24 v33, 205, v32
    v_lshrrev_b32 v33, 10, v33
    v_mul_u32_u24 v34, 5, v33
    v_sub_u32 v34, v32, v34
    v_lshlrev_b32 v35, 2, v34
    v_lshrrev_b32 v35, v35, s6
    v_and_b32 v35, 15, v35
    v_xor_b32 v35, v35, v1
    v_mul_lo_u32 v33, v33, s7
    v_lshl_add_u32 v33, v34, 9, v33
    v_lshl_add_u32 v11, v35, 4, v33
    v_add_u32 v32, 8, v2
    v_add_u32 v32, s5, v32
    v_mul_u32_u24 v33, 205, v32
    v_lshrrev_b32 v33, 10, v33
    v_mul_u32_u24 v34, 5, v33
    v_sub_u32 v34, v32, v34
    v_lshlrev_b32 v35, 2, v34
    v_lshrrev_b32 v35, v35, s6
    v_and_b32 v35, 15, v35
    v_xor_b32 v35, v35, v1
    v_mul_lo_u32 v33, v33, s7
    v_lshl_add_u32 v33, v34, 9, v33
    v_lshl_add_u32 v12, v35, 4, v33
    v_add_u32 v32, 10, v2
    v_add_u32 v32, s5, v32
    v_mul_u32_u24 v33, 205, v32
    v_lshrrev_b32 v33, 10, v33
    v_mul_u32_u24 v34, 5, v33
    v_sub_u32 v34, v32, v34
    v_lshlrev_b32 v35, 2, v34
    v_lshrrev_b32 v35, v35, s6
    v_and_b32 v35, 15, v35
    v_xor_b32 v35, v35, v1
    v_mul_lo_u32 v33, v33, s7
    v_lshl_add_u32 v33, v34, 9, v33
    v_lshl_add_u32 v13, v35, 4, v33
    v_add_u32 v32, 12, v2
    v_add_u32 v32, s5, v32
    v_mul_u32_u24 v33, 205, v32
    v_lshrrev_b32 v33, 10, v33
    v_mul_u32_u24 v34, 5, v33
    v_sub_u32 v34, v32, v34
    v_lshlrev_b32 v35, 2, v34
    v_lshrrev_b32 v35, v35, s6
    v_and_b32 v35, 15, v35
    v_xor_b32 v35, v35, v1
    v_mul_lo_u32 v33, v33, s7
    v_lshl_add_u32 v33, v34, 9, v33
    v_lshl_add_u32 v14, v35, 4, v33
    v_add_u32 v32, 14, v2
    v_add_u32 v32, s5, v32
    v_mul_u32_u24 v33, 205, v32
    v_lshrrev_b32 v33, 10, v33
    v_mul_u32_u24 v34, 5, v33
    v_sub_u32 v34, v32, v34
    v_lshlrev_b32 v35, 2, v34
    v_lshrrev_b32 v35, v35, s6
    v_and_b32 v35, 15, v35
    v_xor_b32 v35, v35, v1
    v_mul_lo_u32 v33, v33, s7
    v_lshl_add_u32 v33, v34, 9, v33
    v_lshl_add_u32 v15, v35, 4, v33
    s_waitcnt lgkmcnt(0)
    s_barrier
    ds_read_b64_tr_b16 v[32:33], v20 offset:32768
    ds_read_b64_tr_b16 v[34:35], v20 offset:33792
    ds_read_b64_tr_b16 v[36:37], v21 offset:32768
    ds_read_b64_tr_b16 v[38:39], v21 offset:33792
    ds_read_b64_tr_b16 v[40:41], v22 offset:32768
    ds_read_b64_tr_b16 v[42:43], v22 offset:33792
    ds_read_b64_tr_b16 v[44:45], v23 offset:32768
    ds_read_b64_tr_b16 v[46:47], v23 offset:33792
    ds_read_b128 v[128:131], v16 offset:0
    ds_read_b64_tr_b16 v[48:49], v20 offset:36864
    ds_read_b64_tr_b16 v[50:51], v20 offset:37888
    ds_read_b64_tr_b16 v[52:53], v21 offset:36864
    ds_read_b64_tr_b16 v[54:55], v21 offset:37888
    ds_read_b64_tr_b16 v[56:57], v22 offset:36864
    ds_read_b64_tr_b16 v[58:59], v22 offset:37888
    ds_read_b64_tr_b16 v[60:61], v23 offset:36864
    ds_read_b64_tr_b16 v[62:63], v23 offset:37888
    ds_read_b128 v[132:135], v17 offset:0
    s_waitcnt lgkmcnt(9)
    v_mfma_f32_32x32x16_bf16 v[64:79], v[32:35], v[128:131], 0
    ds_read_b64_tr_b16 v[32:33], v20 offset:40960
    ds_read_b64_tr_b16 v[34:35], v20 offset:41984
    v_mfma_f32_32x32x16_bf16 v[80:95], v[36:39], v[128:131], 0
    ds_read_b64_tr_b16 v[36:37], v21 offset:40960
    ds_read_b64_tr_b16 v[38:39], v21 offset:41984
    v_mfma_f32_32x32x16_bf16 v[96:111], v[40:43], v[128:131], 0
    ds_read_b64_tr_b16 v[40:41], v22 offset:40960
    ds_read_b64_tr_b16 v[42:43], v22 offset:41984
    v_mfma_f32_32x32x16_bf16 v[112:127], v[44:47], v[128:131], 0
    ds_read_b64_tr_b16 v[44:45], v23 offset:40960
    ds_read_b64_tr_b16 v[46:47], v23 offset:41984
    ds_read_b128 v[136:139], v18 offset:0
    s_waitcnt lgkmcnt(9)
    v_mfma_f32_32x32x16_bf16 v[64:79], v[48:51], v[132:135], v[64:79]
    ds_read_b64_tr_b16 v[48:49], v20 offset:45056
    ds_read_b64_tr_b16 v[50:51], v20 offset:46080
    v_mfma_f32_32x32x16_bf16 v[80:95], v[52:55], v[132:135], v[80:95]
    ds_read_b64_tr_b16 v[52:53], v21 offset:45056
    ds_read_b64_tr_b16 v[54:55], v21 offset:46080
    v_mfma_f32_32x32x16_bf16 v[96:111], v[56:59], v[132:135], v[96:111]
    ds_read_b64_tr_b16 v[56:57], v22 offset:45056
    ds_read_b64_tr_b16 v[58:59], v22 offset:46080
    v_mfma_f32_32x32x16_bf16 v[112:127], v[60:63], v[132:135], v[112:127]
    ds_read_b64_tr_b16 v[60:61], v23 offset:45056
    ds_read_b64_tr_b16 v[62:63], v23 offset:46080
    ds_read_b128 v[140:143], v19 offset:0
    s_waitcnt lgkmcnt(9)
    v_mfma_f32_32x32x16_bf16 v[64:79], v[32:35], v[136:139], v[64:79]
    s_barrier
    ds_read_b64_tr_b16 v[32:33], v20 offset:49152
    ds_read_b64_tr_b16 v[34:35], v20 offset:50176
    v_mfma_f32_32x32x16_bf16 v[80:95], v[36:39], v[136:139], v[80:95]
    ds_read_b64_tr_b16 v[36:37], v21 offset:49152
    ds_read_b64_tr_b16 v[38:39], v21 offset:50176
    v_mfma_f32_32x32x16_bf16 v[96:111], v[40:43], v[136:139], v[96:111]
    ds_read_b64_tr_b16 v[40:41], v22 offset:49152
    ds_read_b64_tr_b16 v[42:43], v22 offset:50176
    v_mfma_f32_32x32x16_bf16 v[112:127], v[44:47], v[136:139], v[112:127]
    ds_read_b64_tr_b16 v[44:45], v23 offset:49152
    ds_read_b64_tr_b16 v[46:47], v23 offset:50176
    ds_read_b128 v[144:147], v16 offset:16384
    s_waitcnt lgkmcnt(9)
    v_mfma_f32_32x32x16_bf16 v[64:79], v[48:51], v[140:143], v[64:79]
    ds_read_b64_tr_b16 v[48:49], v20 offset:53248
    ds_read_b64_tr_b16 v[50:51], v20 offset:54272
    v_mfma_f32_32x32x16_bf16 v[80:95], v[52:55], v[140:143], v[80:95]
    ds_read_b64_tr_b16 v[52:53], v21 offset:53248
    ds_read_b64_tr_b16 v[54:55], v21 offset:54272
    v_mfma_f32_32x32x16_bf16 v[96:111], v[56:59], v[140:143], v[96:111]
    ds_read_b64_tr_b16 v[56:57], v22 offset:53248
    ds_read_b64_tr_b16 v[58:59], v22 offset:54272
    v_mfma_f32_32x32x16_bf16 v[112:127], v[60:63], v[140:143], v[112:127]
    ds_read_b64_tr_b16 v[60:61], v23 offset:53248
    ds_read_b64_tr_b16 v[62:63], v23 offset:54272
    ds_read_b128 v[148:151], v17 offset:16384
    s_waitcnt lgkmcnt(9)
    v_mfma_f32_32x32x16_bf16 v[64:79], v[32:35], v[144:147], v[64:79]
    ds_read_b64_tr_b16 v[32:33], v20 offset:57344
    ds_read_b64_tr_b16 v[34:35], v20 offset:58368
    v_mfma_f32_32x32x16_bf16 v[80:95], v[36:39], v[144:147], v[80:95]
    ds_read_b64_tr_b16 v[36:37], v21 offset:57344
    ds_read_b64_tr_b16 v[38:39], v21 offset:58368
    v_mfma_f32_32x32x16_bf16 v[96:111], v[40:43], v[144:147], v[96:111]
    ds_read_b64_tr_b16 v[40:41], v22 offset:57344
    ds_read_b64_tr_b16 v[42:43], v22 offset:58368
    v_mfma_f32_32x32x16_bf16 v[112:127], v[44:47], v[144:147], v[112:127]
    ds_read_b64_tr_b16 v[44:45], v23 offset:57344
    ds_read_b64_tr_b16 v[46:47], v23 offset:58368
    ds_read_b128 v[152:155], v18 offset:16384
    s_waitcnt lgkmcnt(9)
    v_mfma_f32_32x32x16_bf16 v[64:79], v[48:51], v[148:151], v[64:79]
    ds_read_b64_tr_b16 v[48:49], v20 offset:61440
    ds_read_b64_tr_b16 v[50:51], v20 offset:62464
    v_mfma_f32_32x32x16_bf16 v[80:95], v[52:55], v[148:151], v[80:95]
    ds_read_b64_tr_b16 v[52:53], v21 offset:61440
    ds_read_b64_tr_b16 v[54:55], v21 offset:62464
    v_mfma_f32_32x32x16_bf16 v[96:111], v[56:59], v[148:151], v[96:111]
    ds_read_b64_tr_b16 v[56:57], v22 offset:61440
    ds_read_b64_tr_b16 v[58:59], v22 offset:62464
    v_mfma_f32_32x32x16_bf16 v[112:127], v[60:63], v[148:151], v[112:127]
    ds_read_b64_tr_b16 v[60:61], v23 offset:61440
    ds_read_b64_tr_b16 v[62:63], v23 offset:62464
    ds_read_b128 v[156:159], v19 offset:16384
    s_waitcnt lgkmcnt(9)
    v_mfma_f32_32x32x16_bf16 v[64:79], v[32:35], v[152:155], v[64:79]
    s_barrier
    ds_read_b64_tr_b16 v[32:33], v20 offset:0
    ds_read_b64_tr_b16 v[34:35], v20 offset:1024
    v_mfma_f32_32x32x16_bf16 v[80:95], v[36:39], v[152:155], v[80:95]
    ds_read_b64_tr_b16 v[36:37], v21 offset:0
    ds_read_b64_tr_b16 v[38:39], v21 offset:1024
    v_mfma_f32_32x32x16_bf16 v[96:111], v[40:43], v[152:155], v[96:111]
    ds_read_b64_tr_b16 v[40:41], v22 offset:0
    ds_read_b64_tr_b16 v[42:43], v22 offset:1024
    v_mfma_f32_32x32x16_bf16 v[112:127], v[44:47], v[152:155], v[112:127]
    ds_read_b64_tr_b16 v[44:45], v23 offset:0
    ds_read_b64_tr_b16 v[46:47], v23 offset:1024
    ds_read_b128 v[160:163], v16 offset:49152
    s_waitcnt lgkmcnt(9)
    v_mfma_f32_32x32x16_bf16 v[64:79], v[48:51], v[156:159], v[64:79]
    ds_read_b64_tr_b16 v[48:49], v20 offset:4096
    ds_read_b64_tr_b16 v[50:51], v20 offset:5120
    v_mfma_f32_32x32x16_bf16 v[80:95], v[52:55], v[156:159], v[80:95]
    ds_read_b64_tr_b16 v[52:53], v21 offset:4096
    ds_read_b64_tr_b16 v[54:55], v21 offset:5120
    v_mfma_f32_32x32x16_bf16 v[96:111], v[56:59], v[156:159], v[96:111]
    ds_read_b64_tr_b16 v[56:57], v22 offset:4096
    ds_read_b64_tr_b16 v[58:59], v22 offset:5120
    v_mfma_f32_32x32x16_bf16 v[112:127], v[60:63], v[156:159], v[112:127]
    ds_read_b64_tr_b16 v[60:61], v23 offset:4096
    ds_read_b64_tr_b16 v[62:63], v23 offset:5120
    ds_read_b128 v[164:167], v17 offset:49152
    s_waitcnt lgkmcnt(9)
    v_mfma_f32_32x32x16_bf16 v[64:79], v[32:35], v[160:163], v[64:79]
    ds_read_b64_tr_b16 v[32:33], v20 offset:8192
    ds_read_b64_tr_b16 v[34:35], v20 offset:9216
    v_mfma_f32_32x32x16_bf16 v[80:95], v[36:39], v[160:163], v[80:95]
    ds_read_b64_tr_b16 v[36:37], v21 offset:8192
    ds_read_b64_tr_b16 v[38:39], v21 offset:9216
    v_mfma_f32_32x32x16_bf16 v[96:111], v[40:43], v[160:163], v[96:111]
    ds_read_b64_tr_b16 v[40:41], v22 offset:8192
    ds_read_b64_tr_b16 v[42:43], v22 offset:9216
    v_mfma_f32_32x32x16_bf16 v[112:127], v[44:47], v[160:163], v[112:127]
    ds_read_b64_tr_b16 v[44:45], v23 offset:8192
    ds_read_b64_tr_b16 v[46:47], v23 offset:9216
    ds_read_b128 v[168:171], v18 offset:49152
    s_waitcnt lgkmcnt(9)
    v_mfma_f32_32x32x16_bf16 v[64:79], v[48:51], v[164:167], v[64:79]
    ds_read_b64_tr_b16 v[48:49], v20 offset:12288
    ds_read_b64_tr_b16 v[50:51], v20 offset:13312
    v_mfma_f32_32x32x16_bf16 v[80:95], v[52:55], v[164:167], v[80:95]
    ds_read_b64_tr_b16 v[52:53], v21 offset:12288
    ds_read_b64_tr_b16 v[54:55], v21 offset:13312
    v_mfma_f32_32x32x16_bf16 v[96:111], v[56:59], v[164:167], v[96:111]
    ds_read_b64_tr_b16 v[56:57], v22 offset:12288
    ds_read_b64_tr_b16 v[58:59], v22 offset:13312
    v_mfma_f32_32x32x16_bf16 v[112:127], v[60:63], v[164:167], v[112:127]
    ds_read_b64_tr_b16 v[60:61], v23 offset:12288
    ds_read_b64_tr_b16 v[62:63], v23 offset:13312
    ds_read_b128 v[172:175], v19 offset:49152
    s_waitcnt lgkmcnt(9)
    v_mfma_f32_32x32x16_bf16 v[64:79], v[32:35], v[168:171], v[64:79]
    s_barrier
    ds_read_b64_tr_b16 v[32:33], v20 offset:16384
    ds_read_b64_tr_b16 v[34:35], v20 offset:17408
    v_mfma_f32_32x32x16_bf16 v[80:95], v[36:39], v[168:171], v[80:95]
    ds_read_b64_tr_b16 v[36:37], v21 offset:16384
    ds_read_b64_tr_b16 v[38:39], v21 offset:17408
    v_mfma_f32_32x32x16_bf16 v[96:111], v[40:43], v[168:171], v[96:111]
    ds_read_b64_tr_b16 v[40:41], v22 offset:16384
    ds_read_b64_tr_b16 v[42:43], v22 offset:17408
    v_mfma_f32_32x32x16_bf16 v[112:127], v[44:47], v[168:171], v[112:127]
    ds_read_b64_tr_b16 v[44:45], v23 offset:16384
    ds_read_b64_tr_b16 v[46:47], v23 offset:17408
    ds_read_b128 v[176:179], v16 offset:32768
    s_waitcnt lgkmcnt(9)
    v_mfma_f32_32x32x16_bf16 v[64:79], v[48:51], v[172:175], v[64:79]
    ds_read_b64_tr_b16 v[48:49], v20 offset:20480
    ds_read_b64_tr_b16 v[50:51], v20 offset:21504
    v_mfma_f32_32x32x16_bf16 v[80:95], v[52:55], v[172:175], v[80:95]
    ds_read_b64_tr_b16 v[52:53], v21 offset:20480
    ds_read_b64_tr_b16 v[54:55], v21 offset:21504
    v_mfma_f32_32x32x16_bf16 v[96:111], v[56:59], v[172:175], v[96:111]
    ds_read_b64_tr_b16 v[56:57], v22 offset:20480
    ds_read_b64_tr_b16 v[58:59], v22 offset:21504
    v_mfma_f32_32x32x16_bf16 v[112:127], v[60:63], v[172:175], v[112:127]
    ds_read_b64_tr_b16 v[60:61], v23 offset:20480
    ds_read_b64_tr_b16 v[62:63], v23 offset:21504
    ds_read_b128 v[180:183], v17 offset:32768
    s_waitcnt lgkmcnt(9)
    v_mfma_f32_32x32x16_bf16 v[64:79], v[32:35], v[176:179], v[64:79]
    ds_read_b64_tr_b16 v[32:33], v20 offset:24576
    ds_read_b64_tr_b16 v[34:35], v20 offset:25600
    v_mfma_f32_32x32x16_bf16 v[80:95], v[36:39], v[176:179], v[80:95]
    ds_read_b64_tr_b16 v[36:37], v21 offset:24576
    ds_read_b64_tr_b16 v[38:39], v21 offset:25600
    v_mfma_f32_32x32x16_bf16 v[96:111], v[40:43], v[176:179], v[96:111]
    ds_read_b64_tr_b16 v[40:41], v22 offset:24576
    ds_read_b64_tr_b16 v[42:43], v22 offset:25600
    v_mfma_f32_32x32x16_bf16 v[112:127], v[44:47], v[176:179], v[112:127]
    ds_read_b64_tr_b16 v[44:45], v23 offset:24576
    ds_read_b64_tr_b16 v[46:47], v23 offset:25600
    ds_read_b128 v[184:187], v18 offset:32768
    s_waitcnt lgkmcnt(9)
    v_mfma_f32_32x32x16_bf16 v[64:79], v[48:51], v[180:183], v[64:79]
    ds_read_b64_tr_b16 v[48:49], v20 offset:28672
    ds_read_b64_tr_b16 v[50:51], v20 offset:29696
    v_mfma_f32_32x32x16_bf16 v[80:95], v[52:55], v[180:183], v[80:95]
    ds_read_b64_tr_b16 v[52:53], v21 offset:28672
    ds_read_b64_tr_b16 v[54:55], v21 offset:29696
    v_mfma_f32_32x32x16_bf16 v[96:111], v[56:59], v[180:183], v[96:111]
    ds_read_b64_tr_b16 v[56:57], v22 offset:28672
    ds_read_b64_tr_b16 v[58:59], v22 offset:29696
    v_mfma_f32_32x32x16_bf16 v[112:127], v[60:63], v[180:183], v[112:127]
    ds_read_b64_tr_b16 v[60:61], v23 offset:28672
    ds_read_b64_tr_b16 v[62:63], v23 offset:29696
    ds_read_b128 v[188:191], v19 offset:32768
    s_waitcnt lgkmcnt(9)
    v_mfma_f32_32x32x16_bf16 v[64:79], v[32:35], v[184:187], v[64:79]
    s_barrier
    ds_read_b64_tr_b16 v[32:33], v20 offset:32768
    ds_read_b64_tr_b16 v[34:35], v20 offset:33792
    v_mfma_f32_32x32x16_bf16 v[80:95], v[36:39], v[184:187], v[80:95]
    ds_read_b64_tr_b16 v[36:37], v21 offset:32768
    ds_read_b64_tr_b16 v[38:39], v21 offset:33792
    v_mfma_f32_32x32x16_bf16 v[96:111], v[40:43], v[184:187], v[96:111]
    ds_read_b64_tr_b16 v[40:41], v22 offset:32768
    ds_read_b64_tr_b16 v[42:43], v22 offset:33792
    v_mfma_f32_32x32x16_bf16 v[112:127], v[44:47], v[184:187], v[112:127]
    ds_read_b64_tr_b16 v[44:45], v23 offset:32768
    ds_read_b64_tr_b16 v[46:47], v23 offset:33792
    ds_read_b128 v[192:195], v16 offset:0
    s_waitcnt lgkmcnt(9)
    v_mfma_f32_32x32x16_bf16 v[64:79], v[48:51], v[188:191], v[64:79]
    ds_read_b64_tr_b16 v[48:49], v20 offset:36864
    ds_read_b64_tr_b16 v[50:51], v20 offset:37888
    v_mfma_f32_32x32x16_bf16 v[80:95], v[52:55], v[188:191], v[80:95]
    ds_read_b64_tr_b16 v[52:53], v21 offset:36864
    ds_read_b64_tr_b16 v[54:55], v21 offset:37888
    v_mfma_f32_32x32x16_bf16 v[96:111], v[56:59], v[188:191], v[96:111]
    ds_read_b64_tr_b16 v[56:57], v22 offset:36864
    ds_read_b64_tr_b16 v[58:59], v22 offset:37888
    v_mfma_f32_32x32x16_bf16 v[112:127], v[60:63], v[188:191], v[112:127]
    ds_read_b64_tr_b16 v[60:61], v23 offset:36864
    ds_read_b64_tr_b16 v[62:63], v23 offset:37888
    ds_read_b128 v[196:199], v17 offset:0
    s_waitcnt lgkmcnt(9)
    v_mfma_f32_32x32x16_bf16 v[64:79], v[32:35], v[192:195], v[64:79]
    ds_read_b64_tr_b16 v[32:33], v20 offset:40960
    ds_read_b64_tr_b16 v[34:35], v20 offset:41984
    v_mfma_f32_32x32x16_bf16 v[80:95], v[36:39], v[192:195], v[80:95]
    ds_read_b64_tr_b16 v[36:37], v21 offset:40960
    ds_read_b64_tr_b16 v[38:39], v21 offset:41984
    v_mfma_f32_32x32x16_bf16 v[96:111], v[40:43], v[192:195], v[96:111]
    ds_read_b64_tr_b16 v[40:41], v22 offset:40960
    ds_read_b64_tr_b16 v[42:43], v22 offset:41984
    v_mfma_f32_32x32x16_bf16 v[112:127], v[44:47], v[192:195], v[112:127]
    ds_read_b64_tr_b16 v[44:45], v23 offset:40960
    ds_read_b64_tr_b16 v[46:47], v23 offset:41984
    ds_read_b128 v[200:203], v18 offset:0
    s_waitcnt lgkmcnt(9)
    v_mfma_f32_32x32x16_bf16 v[64:79], v[48:51], v[196:199], v[64:79]
    ds_read_b64_tr_b16 v[48:49], v20 offset:45056
    ds_read_b64_tr_b16 v[50:51], v20 offset:46080
    v_mfma_f32_32x32x16_bf16 v[80:95], v[52:55], v[196:199], v[80:95]
    ds_read_b64_tr_b16 v[52:53], v21 offset:45056
    ds_read_b64_tr_b16 v[54:55], v21 offset:46080
    v_mfma_f32_32x32x16_bf16 v[96:111], v[56:59], v[196:199], v[96:111]
    ds_read_b64_tr_b16 v[56:57], v22 offset:45056
    ds_read_b64_tr_b16 v[58:59], v22 offset:46080
    v_mfma_f32_32x32x16_bf16 v[112:127], v[60:63], v[196:199], v[112:127]
    ds_read_b64_tr_b16 v[60:61], v23 offset:45056
    ds_read_b64_tr_b16 v[62:63], v23 offset:46080
    ds_read_b128 v[204:207], v19 offset:0
    s_waitcnt lgkmcnt(9)
    v_mfma_f32_32x32x16_bf16 v[64:79], v[32:35], v[200:203], v[64:79]
    s_barrier
    ds_read_b64_tr_b16 v[32:33], v20 offset:49152
    ds_read_b64_tr_b16 v[34:35], v20 offset:50176
    v_mfma_f32_32x32x16_bf16 v[80:95], v[36:39], v[200:203], v[80:95]
    ds_read_b64_tr_b16 v[36:37], v21 offset:49152
    ds_read_b64_tr_b16 v[38:39], v21 offset:50176
    v_mfma_f32_32x32x16_bf16 v[96:111], v[40:43], v[200:203], v[96:111]
    ds_read_b64_tr_b16 v[40:41], v22 offset:49152
    ds_read_b64_tr_b16 v[42:43], v22 offset:50176
    v_mfma_f32_32x32x16_bf16 v[112:127], v[44:47], v[200:203], v[112:127]
    ds_read_b64_tr_b16 v[44:45], v23 offset:49152
    ds_read_b64_tr_b16 v[46:47], v23 offset:50176
    ds_read_b128 v[208:211], v16 offset:16384
    s_waitcnt lgkmcnt(9)
    v_mfma_f32_32x32x16_bf16 v[64:79], v[48:51], v[204:207], v[64:79]
    ds_read_b64_tr_b16 v[48:49], v20 offset:53248
    ds_read_b64_tr_b16 v[50:51], v20 offset:54272
    v_mfma_f32_32x32x16_bf16 v[80:95], v[52:55], v[204:207], v[80:95]
    ds_read_b64_tr_b16 v[52:53], v21 offset:53248
    ds_read_b64_tr_b16 v[54:55], v21 offset:54272
    v_mfma_f32_32x32x16_bf16 v[96:111], v[56:59], v[204:207], v[96:111]
    ds_read_b64_tr_b16 v[56:57], v22 offset:53248
    ds_read_b64_tr_b16 v[58:59], v22 offset:54272
    v_mfma_f32_32x32x16_bf16 v[112:127], v[60:63], v[204:207], v[112:127]
    ds_read_b64_tr_b16 v[60:61], v23 offset:53248
    ds_read_b64_tr_b16 v[62:63], v23 offset:54272
    ds_read_b128 v[212:215], v17 offset:16384
    s_waitcnt lgkmcnt(9)
    v_mfma_f32_32x32x16_bf16 v[64:79], v[32:35], v[208:211], v[64:79]
    ds_read_b64_tr_b16 v[32:33], v20 offset:57344
    ds_read_b64_tr_b16 v[34:35], v20 offset:58368
    v_mfma_f32_32x32x16_bf16 v[80:95], v[36:39], v[208:211], v[80:95]
    ds_read_b64_tr_b16 v[36:37], v21 offset:57344
    ds_read_b64_tr_b16 v[38:39], v21 offset:58368
    v_mfma_f32_32x32x16_bf16 v[96:111], v[40:43], v[208:211], v[96:111]
    ds_read_b64_tr_b16 v[40:41], v22 offset:57344
    ds_read_b64_tr_b16 v[42:43], v22 offset:58368
    v_mfma_f32_32x32x16_bf16 v[112:127], v[44:47], v[208:211], v[112:127]
    ds_read_b64_tr_b16 v[44:45], v23 offset:57344
    ds_read_b64_tr_b16 v[46:47], v23 offset:58368
    ds_read_b128 v[216:219], v18 offset:16384
    s_waitcnt lgkmcnt(9)
    v_mfma_f32_32x32x16_bf16 v[64:79], v[48:51], v[212:215], v[64:79]
    ds_read_b64_tr_b16 v[48:49], v20 offset:61440
    ds_read_b64_tr_b16 v[50:51], v20 offset:62464
    v_mfma_f32_32x32x16_bf16 v[80:95], v[52:55], v[212:215], v[80:95]
    ds_read_b64_tr_b16 v[52:53], v21 offset:61440
    ds_read_b64_tr_b16 v[54:55], v21 offset:62464
    v_mfma_f32_32x32x16_bf16 v[96:111], v[56:59], v[212:215], v[96:111]
    ds_read_b64_tr_b16 v[56:57], v22 offset:61440
    ds_read_b64_tr_b16 v[58:59], v22 offset:62464
    v_mfma_f32_32x32x16_bf16 v[112:127], v[60:63], v[212:215], v[112:127]
    ds_read_b64_tr_b16 v[60:61], v23 offset:61440
    ds_read_b64_tr_b16 v[62:63], v23 offset:62464
    ds_read_b128 v[220:223], v19 offset:16384
    s_waitcnt lgkmcnt(9)
    v_mfma_f32_32x32x16_bf16 v[64:79], v[32:35], v[216:219], v[64:79]
    s_barrier
    ds_read_b64_tr_b16 v[32:33], v20 offset:0
    ds_read_b64_tr_b16 v[34:35], v20 offset:1024
    v_mfma_f32_32x32x16_bf16 v[80:95], v[36:39], v[216:219], v[80:95]
    ds_read_b64_tr_b16 v[36:37], v21 offset:0
    ds_read_b64_tr_b16 v[38:39], v21 offset:1024
    v_mfma_f32_32x32x16_bf16 v[96:111], v[40:43], v[216:219], v[96:111]
    ds_read_b64_tr_b16 v[40:41], v22 offset:0
    ds_read_b64_tr_b16 v[42:43], v22 offset:1024
    v_mfma_f32_32x32x16_bf16 v[112:127], v[44:47], v[216:219], v[112:127]
    ds_read_b64_tr_b16 v[44:45], v23 offset:0
    ds_read_b64_tr_b16 v[46:47], v23 offset:1024
    ds_read_b128 v[224:227], v16 offset:49152
    s_waitcnt lgkmcnt(9)
    v_mfma_f32_32x32x16_bf16 v[64:79], v[48:51], v[220:223], v[64:79]
    ds_read_b64_tr_b16 v[48:49], v20 offset:4096
    ds_read_b64_tr_b16 v[50:51], v20 offset:5120
    v_mfma_f32_32x32x16_bf16 v[80:95], v[52:55], v[220:223], v[80:95]
    ds_read_b64_tr_b16 v[52:53], v21 offset:4096
    ds_read_b64_tr_b16 v[54:55], v21 offset:5120
    v_mfma_f32_32x32x16_bf16 v[96:111], v[56:59], v[220:223], v[96:111]
    ds_read_b64_tr_b16 v[56:57], v22 offset:4096
    ds_read_b64_tr_b16 v[58:59], v22 offset:5120
    v_mfma_f32_32x32x16_bf16 v[112:127], v[60:63], v[220:223], v[112:127]
    ds_read_b64_tr_b16 v[60:61], v23 offset:4096
    ds_read_b64_tr_b16 v[62:63], v23 offset:5120
    ds_read_b128 v[228:231], v17 offset:49152
    s_waitcnt lgkmcnt(9)
    v_mfma_f32_32x32x16_bf16 v[64:79], v[32:35], v[224:227], v[64:79]
    ds_read_b64_tr_b16 v[32:33], v20 offset:8192
    ds_read_b64_tr_b16 v[34:35], v20 offset:9216
    v_mfma_f32_32x32x16_bf16 v[80:95], v[36:39], v[224:227], v[80:95]
    ds_read_b64_tr_b16 v[36:37], v21 offset:8192
    ds_read_b64_tr_b16 v[38:39], v21 offset:9216
    v_mfma_f32_32x32x16_bf16 v[96:111], v[40:43], v[224:227], v[96:111]
    ds_read_b64_tr_b16 v[40:41], v22 offset:8192
    ds_read_b64_tr_b16 v[42:43], v22 offset:9216
    v_mfma_f32_32x32x16_bf16 v[112:127], v[44:47], v[224:227], v[112:127]
    ds_read_b64_tr_b16 v[44:45], v23 offset:8192
    ds_read_b64_tr_b16 v[46:47], v23 offset:9216
    ds_read_b128 v[232:235], v18 offset:49152
    s_waitcnt lgkmcnt(9)
    v_mfma_f32_32x32x16_bf16 v[64:79], v[48:51], v[228:231], v[64:79]
    ds_read_b64_tr_b16 v[48:49], v20 offset:12288
    ds_read_b64_tr_b16 v[50:51], v20 offset:13312
    v_mfma_f32_32x32x16_bf16 v[80:95], v[52:55], v[228:231], v[80:95]
    ds_read_b64_tr_b16 v[52:53], v21 offset:12288
    ds_read_b64_tr_b16 v[54:55], v21 offset:13312
    v_mfma_f32_32x32x16_bf16 v[96:111], v[56:59], v[228:231], v[96:111]
    ds_read_b64_tr_b16 v[56:57], v22 offset:12288
    ds_read_b64_tr_b16 v[58:59], v22 offset:13312
    v_mfma_f32_32x32x16_bf16 v[112:127], v[60:63], v[228:231], v[112:127]
    ds_read_b64_tr_b16 v[60:61], v23 offset:12288
    ds_read_b64_tr_b16 v[62:63], v23 offset:13312
    ds_read_b128 v[236:239], v19 offset:49152
    s_waitcnt lgkmcnt(9)
    v_mfma_f32_32x32x16_bf16 v[64:79], v[32:35], v[232:235], v[64:79]
    s_waitcnt vmcnt(0)
    s_barrier
    ds_read_b64_tr_b16 v[32:33], v20 offset:16384
    ds_read_b64_tr_b16 v[34:35], v20 offset:17408
    v_mfma_f32_32x32x16_bf16 v[80:95], v[36:39], v[232:235], v[80:95]
    ds_read_b64_tr_b16 v[36:37], v21 offset:16384
    ds_read_b64_tr_b16 v[38:39], v21 offset:17408
    v_mfma_f32_32x32x16_bf16 v[96:111], v[40:43], v[232:235], v[96:111]
    ds_read_b64_tr_b16 v[40:41], v22 offset:16384
    ds_read_b64_tr_b16 v[42:43], v22 offset:17408
    v_mfma_f32_32x32x16_bf16 v[112:127], v[44:47], v[232:235], v[112:127]
    ds_read_b64_tr_b16 v[44:45], v23 offset:16384
    ds_read_b64_tr_b16 v[46:47], v23 offset:17408
    ds_read_b128 v[240:243], v16 offset:32768
    s_waitcnt lgkmcnt(9)
    v_mfma_f32_32x32x16_bf16 v[64:79], v[48:51], v[236:239], v[64:79]
    ds_read_b64_tr_b16 v[48:49], v20 offset:20480
    ds_read_b64_tr_b16 v[50:51], v20 offset:21504
    v_mfma_f32_32x32x16_bf16 v[80:95], v[52:55], v[236:239], v[80:95]
    ds_read_b64_tr_b16 v[52:53], v21 offset:20480
    ds_read_b64_tr_b16 v[54:55], v21 offset:21504
    v_mfma_f32_32x32x16_bf16 v[96:111], v[56:59], v[236:239], v[96:111]
    ds_read_b64_tr_b16 v[56:57], v22 offset:20480
    ds_read_b64_tr_b16 v[58:59], v22 offset:21504
    v_mfma_f32_32x32x16_bf16 v[112:127], v[60:63], v[236:239], v[112:127]
    ds_read_b64_tr_b16 v[60:61], v23 offset:20480
    ds_read_b64_tr_b16 v[62:63], v23 offset:21504
    ds_read_b128 v[244:247], v17 offset:32768
    s_waitcnt lgkmcnt(9)
    v_mfma_f32_32x32x16_bf16 v[64:79], v[32:35], v[240:243], v[64:79]
    ds_read_b64_tr_b16 v[32:33], v20 offset:24576
    ds_read_b64_tr_b16 v[34:35], v20 offset:25600
    v_mfma_f32_32x32x16_bf16 v[80:95], v[36:39], v[240:243], v[80:95]
    ds_read_b64_tr_b16 v[36:37], v21 offset:24576
    ds_read_b64_tr_b16 v[38:39], v21 offset:25600
    v_mfma_f32_32x32x16_bf16 v[96:111], v[40:43], v[240:243], v[96:111]
    ds_read_b64_tr_b16 v[40:41], v22 offset:24576
    ds_read_b64_tr_b16 v[42:43], v22 offset:25600
    v_mfma_f32_32x32x16_bf16 v[112:127], v[44:47], v[240:243], v[112:127]
    ds_read_b64_tr_b16 v[44:45], v23 offset:24576
    ds_read_b64_tr_b16 v[46:47], v23 offset:25600
    ds_read_b128 v[248:251], v18 offset:32768
    s_waitcnt lgkmcnt(9)
    v_mfma_f32_32x32x16_bf16 v[64:79], v[48:51], v[244:247], v[64:79]
    ds_read_b64_tr_b16 v[48:49], v20 offset:28672
    ds_read_b64_tr_b16 v[50:51], v20 offset:29696
    v_mfma_f32_32x32x16_bf16 v[80:95], v[52:55], v[244:247], v[80:95]
    ds_read_b64_tr_b16 v[52:53], v21 offset:28672
    ds_read_b64_tr_b16 v[54:55], v21 offset:29696
    v_mfma_f32_32x32x16_bf16 v[96:111], v[56:59], v[244:247], v[96:111]
    ds_read_b64_tr_b16 v[56:57], v22 offset:28672
    ds_read_b64_tr_b16 v[58:59], v22 offset:29696
    v_mfma_f32_32x32x16_bf16 v[112:127], v[60:63], v[244:247], v[112:127]
    ds_read_b64_tr_b16 v[60:61], v23 offset:28672
    ds_read_b64_tr_b16 v[62:63], v23 offset:29696
    ds_read_b128 v[252:255], v19 offset:32768
    s_waitcnt lgkmcnt(9)
    v_mfma_f32_32x32x16_bf16 v[64:79], v[32:35], v[248:251], v[64:79]
    s_barrier
    ds_read_b64_tr_b16 v[32:33], v20 offset:32768
    ds_read_b64_tr_b16 v[34:35], v20 offset:33792
    v_mfma_f32_32x32x16_bf16 v[80:95], v[36:39], v[248:251], v[80:95]
    ds_read_b64_tr_b16 v[36:37], v21 offset:32768
    ds_read_b64_tr_b16 v[38:39], v21 offset:33792
    v_mfma_f32_32x32x16_bf16 v[96:111], v[40:43], v[248:251], v[96:111]
    ds_read_b64_tr_b16 v[40:41], v22 offset:32768
    ds_read_b64_tr_b16 v[42:43], v22 offset:33792
    v_mfma_f32_32x32x16_bf16 v[112:127], v[44:47], v[248:251], v[112:127]
    ds_read_b64_tr_b16 v[44:45], v23 offset:32768
    ds_read_b64_tr_b16 v[46:47], v23 offset:33792
    ds_read_b128 v[24:27], v16 offset:0
    s_waitcnt lgkmcnt(9)
    v_mfma_f32_32x32x16_bf16 v[64:79], v[48:51], v[252:255], v[64:79]
    ds_read_b64_tr_b16 v[48:49], v20 offset:36864
    ds_read_b64_tr_b16 v[50:51], v20 offset:37888
    v_mfma_f32_32x32x16_bf16 v[80:95], v[52:55], v[252:255], v[80:95]
    ds_read_b64_tr_b16 v[52:53], v21 offset:36864
    ds_read_b64_tr_b16 v[54:55], v21 offset:37888
    v_mfma_f32_32x32x16_bf16 v[96:111], v[56:59], v[252:255], v[96:111]
    ds_read_b64_tr_b16 v[56:57], v22 offset:36864
    ds_read_b64_tr_b16 v[58:59], v22 offset:37888
    v_mfma_f32_32x32x16_bf16 v[112:127], v[60:63], v[252:255], v[112:127]
    ds_read_b64_tr_b16 v[60:61], v23 offset:36864
    ds_read_b64_tr_b16 v[62:63], v23 offset:37888
    ds_read_b128 v[28:31], v17 offset:0
    s_waitcnt lgkmcnt(9)
    v_mfma_f32_32x32x16_bf16 v[64:79], v[32:35], v[24:27], v[64:79]
    ds_read_b64_tr_b16 v[32:33], v20 offset:40960
    ds_read_b64_tr_b16 v[34:35], v20 offset:41984
    v_mfma_f32_32x32x16_bf16 v[80:95], v[36:39], v[24:27], v[80:95]
    ds_read_b64_tr_b16 v[36:37], v21 offset:40960
    ds_read_b64_tr_b16 v[38:39], v21 offset:41984
    v_mfma_f32_32x32x16_bf16 v[96:111], v[40:43], v[24:27], v[96:111]
    ds_read_b64_tr_b16 v[40:41], v22 offset:40960
    ds_read_b64_tr_b16 v[42:43], v22 offset:41984
    v_mfma_f32_32x32x16_bf16 v[112:127], v[44:47], v[24:27], v[112:127]
    ds_read_b64_tr_b16 v[44:45], v23 offset:40960
    ds_read_b64_tr_b16 v[46:47], v23 offset:41984
    ds_read_b128 v[24:27], v18 offset:0
    s_waitcnt lgkmcnt(9)
    v_mfma_f32_32x32x16_bf16 v[64:79], v[48:51], v[28:31], v[64:79]
    ds_read_b64_tr_b16 v[48:49], v20 offset:45056
    ds_read_b64_tr_b16 v[50:51], v20 offset:46080
    v_mfma_f32_32x32x16_bf16 v[80:95], v[52:55], v[28:31], v[80:95]
    ds_read_b64_tr_b16 v[52:53], v21 offset:45056
    ds_read_b64_tr_b16 v[54:55], v21 offset:46080
    v_mfma_f32_32x32x16_bf16 v[96:111], v[56:59], v[28:31], v[96:111]
    ds_read_b64_tr_b16 v[56:57], v22 offset:45056
    ds_read_b64_tr_b16 v[58:59], v22 offset:46080
    v_mfma_f32_32x32x16_bf16 v[112:127], v[60:63], v[28:31], v[112:127]
    ds_read_b64_tr_b16 v[60:61], v23 offset:45056
    ds_read_b64_tr_b16 v[62:63], v23 offset:46080
    ds_read_b128 v[28:31], v19 offset:0
    s_waitcnt lgkmcnt(9)
    v_mfma_f32_32x32x16_bf16 v[64:79], v[32:35], v[24:27], v[64:79]
    s_barrier
    ds_read_b64_tr_b16 v[32:33], v20 offset:49152
    ds_read_b64_tr_b16 v[34:35], v20 offset:50176
    v_mfma_f32_32x32x16_bf16 v[80:95], v[36:39], v[24:27], v[80:95]
    ds_read_b64_tr_b16 v[36:37], v21 offset:49152
    ds_read_b64_tr_b16 v[38:39], v21 offset:50176
    v_mfma_f32_32x32x16_bf16 v[96:111], v[40:43], v[24:27], v[96:111]
    ds_read_b64_tr_b16 v[40:41], v22 offset:49152
    ds_read_b64_tr_b16 v[42:43], v22 offset:50176
    v_mfma_f32_32x32x16_bf16 v[112:127], v[44:47], v[24:27], v[112:127]
    ds_read_b64_tr_b16 v[44:45], v23 offset:49152
    ds_read_b64_tr_b16 v[46:47], v23 offset:50176
    ds_read_b128 v[24:27], v16 offset:16384
    s_waitcnt lgkmcnt(9)
    v_mfma_f32_32x32x16_bf16 v[64:79], v[48:51], v[28:31], v[64:79]
    ds_read_b64_tr_b16 v[48:49], v20 offset:53248
    ds_read_b64_tr_b16 v[50:51], v20 offset:54272
    v_mfma_f32_32x32x16_bf16 v[80:95], v[52:55], v[28:31], v[80:95]
    ds_read_b64_tr_b16 v[52:53], v21 offset:53248
    ds_read_b64_tr_b16 v[54:55], v21 offset:54272
    v_mfma_f32_32x32x16_bf16 v[96:111], v[56:59], v[28:31], v[96:111]
    ds_read_b64_tr_b16 v[56:57], v22 offset:53248
    ds_read_b64_tr_b16 v[58:59], v22 offset:54272
    v_mfma_f32_32x32x16_bf16 v[112:127], v[60:63], v[28:31], v[112:127]
    ds_read_b64_tr_b16 v[60:61], v23 offset:53248
    ds_read_b64_tr_b16 v[62:63], v23 offset:54272
    ds_read_b128 v[28:31], v17 offset:16384
    s_waitcnt lgkmcnt(9)
    v_mfma_f32_32x32x16_bf16 v[64:79], v[32:35], v[24:27], v[64:79]
    ds_read_b64_tr_b16 v[32:33], v20 offset:57344
    ds_read_b64_tr_b16 v[34:35], v20 offset:58368
    v_mfma_f32_32x32x16_bf16 v[80:95], v[36:39], v[24:27], v[80:95]
    ds_read_b64_tr_b16 v[36:37], v21 offset:57344
    ds_read_b64_tr_b16 v[38:39], v21 offset:58368
    v_mfma_f32_32x32x16_bf16 v[96:111], v[40:43], v[24:27], v[96:111]
    ds_read_b64_tr_b16 v[40:41], v22 offset:57344
    ds_read_b64_tr_b16 v[42:43], v22 offset:58368
    v_mfma_f32_32x32x16_bf16 v[112:127], v[44:47], v[24:27], v[112:127]
    ds_read_b64_tr_b16 v[44:45], v23 offset:57344
    ds_read_b64_tr_b16 v[46:47], v23 offset:58368
    ds_read_b128 v[24:27], v18 offset:16384
    s_waitcnt lgkmcnt(9)
    v_mfma_f32_32x32x16_bf16 v[64:79], v[48:51], v[28:31], v[64:79]
    ds_read_b64_tr_b16 v[48:49], v20 offset:61440
    ds_read_b64_tr_b16 v[50:51], v20 offset:62464
    v_mfma_f32_32x32x16_bf16 v[80:95], v[52:55], v[28:31], v[80:95]
    ds_read_b64_tr_b16 v[52:53], v21 offset:61440
    ds_read_b64_tr_b16 v[54:55], v21 offset:62464
    v_mfma_f32_32x32x16_bf16 v[96:111], v[56:59], v[28:31], v[96:111]
    ds_read_b64_tr_b16 v[56:57], v22 offset:61440
    ds_read_b64_tr_b16 v[58:59], v22 offset:62464
    v_mfma_f32_32x32x16_bf16 v[112:127], v[60:63], v[28:31], v[112:127]
    ds_read_b64_tr_b16 v[60:61], v23 offset:61440
    ds_read_b64_tr_b16 v[62:63], v23 offset:62464
    ds_read_b128 v[28:31], v19 offset:16384
    s_waitcnt lgkmcnt(9)
    v_mfma_f32_32x32x16_bf16 v[64:79], v[32:35], v[24:27], v[64:79]
    v_mfma_f32_32x32x16_bf16 v[80:95], v[36:39], v[24:27], v[80:95]
    v_mfma_f32_32x32x16_bf16 v[96:111], v[40:43], v[24:27], v[96:111]
    v_mfma_f32_32x32x16_bf16 v[112:127], v[44:47], v[24:27], v[112:127]
    s_waitcnt lgkmcnt(0)
    v_mfma_f32_32x32x16_bf16 v[64:79], v[48:51], v[28:31], v[64:79]
    v_mfma_f32_32x32x16_bf16 v[80:95], v[52:55], v[28:31], v[80:95]
    v_mfma_f32_32x32x16_bf16 v[96:111], v[56:59], v[28:31], v[96:111]
    v_mfma_f32_32x32x16_bf16 v[112:127], v[60:63], v[28:31], v[112:127]
    v_lshlrev_b32 v4, 4, v2
    v_add_u32 v4, 155648, v4
    s_cmp_eq_u32 s49, 15
    s_cbranch_scc1 M_GATE
    s_mov_b32 s60, 1.0
    s_cmp_lt_u32 s49, 5
    s_cselect_b32 s60, 1051011932, s60
    s_mov_b32 s61, s60
    s_mul_i32 s57, s59, 2560
    v_pk_mul_f32 v[64:65], v[64:65], s[60:61]
    v_pk_mul_f32 v[66:67], v[66:67], s[60:61]
    v_pk_mul_f32 v[68:69], v[68:69], s[60:61]
    v_pk_mul_f32 v[70:71], v[70:71], s[60:61]
    v_cvt_pk_bf16_f32 v24, v64, v65
    v_cvt_pk_bf16_f32 v25, v66, v67
    v_cvt_pk_bf16_f32 v26, v68, v69
    v_cvt_pk_bf16_f32 v27, v70, v71
    buffer_store_dwordx4 v[24:27], v8, s[20:23], s57 offen sc1
    v_pk_mul_f32 v[72:73], v[72:73], s[60:61]
    v_pk_mul_f32 v[74:75], v[74:75], s[60:61]
    v_pk_mul_f32 v[76:77], v[76:77], s[60:61]
    v_pk_mul_f32 v[78:79], v[78:79], s[60:61]
    v_cvt_pk_bf16_f32 v28, v72, v73
    v_cvt_pk_bf16_f32 v29, v74, v75
    v_cvt_pk_bf16_f32 v30, v76, v77
    v_cvt_pk_bf16_f32 v31, v78, v79
    buffer_store_dwordx4 v[28:31], v9, s[20:23], s57 offen sc1
    v_pk_mul_f32 v[80:81], v[80:81], s[60:61]
    v_pk_mul_f32 v[82:83], v[82:83], s[60:61]
    v_pk_mul_f32 v[84:85], v[84:85], s[60:61]
    v_pk_mul_f32 v[86:87], v[86:87], s[60:61]
    v_cvt_pk_bf16_f32 v32, v80, v81
    v_cvt_pk_bf16_f32 v33, v82, v83
    v_cvt_pk_bf16_f32 v34, v84, v85
    v_cvt_pk_bf16_f32 v35, v86, v87
    buffer_store_dwordx4 v[32:35], v10, s[20:23], s57 offen sc1
    v_pk_mul_f32 v[88:89], v[88:89], s[60:61]
    v_pk_mul_f32 v[90:91], v[90:91], s[60:61]
    v_pk_mul_f32 v[92:93], v[92:93], s[60:61]
    v_pk_mul_f32 v[94:95], v[94:95], s[60:61]
    v_cvt_pk_bf16_f32 v60, v88, v89
    v_cvt_pk_bf16_f32 v61, v90, v91
    v_cvt_pk_bf16_f32 v62, v92, v93
    v_cvt_pk_bf16_f32 v63, v94, v95
    buffer_store_dwordx4 v[60:63], v11, s[20:23], s57 offen sc1
    v_pk_mul_f32 v[112:113], v[112:113], s[60:61]
    v_pk_mul_f32 v[114:115], v[114:115], s[60:61]
    v_pk_mul_f32 v[116:117], v[116:117], s[60:61]
    v_pk_mul_f32 v[118:119], v[118:119], s[60:61]
    v_cvt_pk_bf16_f32 v112, v112, v113
    v_cvt_pk_bf16_f32 v113, v114, v115
    v_cvt_pk_bf16_f32 v114, v116, v117
    v_cvt_pk_bf16_f32 v115, v118, v119
    buffer_store_dwordx4 v[112:115], v14, s[20:23], s57 offen sc1
    v_pk_mul_f32 v[120:121], v[120:121], s[60:61]
    v_pk_mul_f32 v[122:123], v[122:123], s[60:61]
    v_pk_mul_f32 v[124:125], v[124:125], s[60:61]
    v_pk_mul_f32 v[126:127], v[126:127], s[60:61]
    v_cvt_pk_bf16_f32 v116, v120, v121
    v_cvt_pk_bf16_f32 v117, v122, v123
    v_cvt_pk_bf16_f32 v118, v124, v125
    v_cvt_pk_bf16_f32 v119, v126, v127
    buffer_store_dwordx4 v[116:119], v15, s[20:23], s57 offen sc1
    v_pk_mul_f32 v[96:97], v[96:97], s[60:61]
    v_pk_mul_f32 v[98:99], v[98:99], s[60:61]
    v_pk_mul_f32 v[100:101], v[100:101], s[60:61]
    v_pk_mul_f32 v[102:103], v[102:103], s[60:61]
    v_cvt_pk_bf16_f32 v120, v96, v97
    v_cvt_pk_bf16_f32 v121, v98, v99
    v_cvt_pk_bf16_f32 v122, v100, v101
    v_cvt_pk_bf16_f32 v123, v102, v103
    buffer_store_dwordx4 v[120:123], v12, s[20:23], s57 offen sc1
    v_pk_mul_f32 v[104:105], v[104:105], s[60:61]
    v_pk_mul_f32 v[106:107], v[106:107], s[60:61]
    v_pk_mul_f32 v[108:109], v[108:109], s[60:61]
    v_pk_mul_f32 v[110:111], v[110:111], s[60:61]
    v_cvt_pk_bf16_f32 v124, v104, v105
    v_cvt_pk_bf16_f32 v125, v106, v107
    v_cvt_pk_bf16_f32 v126, v108, v109
    v_cvt_pk_bf16_f32 v127, v110, v111
    buffer_store_dwordx4 v[124:127], v13, s[20:23], s57 offen sc1
    s_branch M_B
M_GATE:
    s_mov_b32 s5, 3216550459
    s_nop 7
    v_permlane32_swap_b32 v65, v32
    v_add_f32 v32, v32, v64
    v_mul_f32 v32, s5, v32
    v_exp_f32 v32, v32
    s_lshl_b32 s62, s59, 7
    v_add_f32 v32, 1.0, v32
    v_rcp_f32 v32, v32
    s_add_u32 s62, s62, 20971520
    v_lshlrev_b32 v33, 2, v0
    s_mov_b32 exec_hi, 0
    buffer_store_dword v32, v33, s[20:23], s62 offen sc1
    s_mov_b32 exec_hi, -1
    s_mov_b32 s57, 0
    v_mov_b32 v8, 0x7f000000
    v_mov_b32 v9, 0x7f000000
    v_mov_b32 v10, 0x7f000000
    v_mov_b32 v11, 0x7f000000
    v_mov_b32 v12, 0x7f000000
    v_mov_b32 v13, 0x7f000000
    v_mov_b32 v14, 0x7f000000
    v_mov_b32 v15, 0x7f000000
    s_branch M_B
M_AV:
    s_sub_u32 s5, s49, 10
    s_lshl_b32 s5, s5, 7
    s_mov_b32 s6, 52429
    s_mov_b32 s7, 81920
    v_mul_u32_u24 v36, 320, v2
    v_add_u32 v32, 0, v1
    v_add_u32 v32, s5, v32
    v_mul_lo_u32 v33, v32, s6
    v_lshrrev_b32 v33, 20, v33
    v_mul_u32_u24 v34, 20, v33
    v_sub_u32 v34, v32, v34
    v_mul_lo_u32 v33, v33, s7
    v_lshl_add_u32 v33, v34, 4, v33
    v_add_u32 v8, v33, v36
    v_add_u32 v9, 640, v8
    v_add_u32 v32, 32, v1
    v_add_u32 v32, s5, v32
    v_mul_lo_u32 v33, v32, s6
    v_lshrrev_b32 v33, 20, v33
    v_mul_u32_u24 v34, 20, v33
    v_sub_u32 v34, v32, v34
    v_mul_lo_u32 v33, v33, s7
    v_lshl_add_u32 v33, v34, 4, v33
    v_add_u32 v10, v33, v36
    v_add_u32 v11, 640, v10
    v_add_u32 v32, 64, v1
    v_add_u32 v32, s5, v32
    v_mul_lo_u32 v33, v32, s6
    v_lshrrev_b32 v33, 20, v33
    v_mul_u32_u24 v34, 20, v33
    v_sub_u32 v34, v32, v34
    v_mul_lo_u32 v33, v33, s7
    v_lshl_add_u32 v33, v34, 4, v33
    v_add_u32 v12, v33, v36
    v_add_u32 v13, 640, v12
    v_add_u32 v32, 96, v1
    v_add_u32 v32, s5, v32
    v_mul_lo_u32 v33, v32, s6
    v_lshrrev_b32 v33, 20, v33
    v_mul_u32_u24 v34, 20, v33
    v_sub_u32 v34, v32, v34
    v_mul_lo_u32 v33, v33, s7
    v_lshl_add_u32 v33, v34, 4, v33
    v_add_u32 v14, v33, v36
    v_add_u32 v15, 640, v14
    s_waitcnt lgkmcnt(0)
    s_barrier
    ds_read_b64_tr_b16 v[32:33], v20 offset:32768
    ds_read_b64_tr_b16 v[34:35], v20 offset:33792
    ds_read_b64_tr_b16 v[36:37], v21 offset:32768
    ds_read_b64_tr_b16 v[38:39], v21 offset:33792
    ds_read_b64_tr_b16 v[40:41], v22 offset:32768
    ds_read_b64_tr_b16 v[42:43], v22 offset:33792
    ds_read_b64_tr_b16 v[44:45], v23 offset:32768
    ds_read_b64_tr_b16 v[46:47], v23 offset:33792
    ds_read_b128 v[128:131], v16 offset:0
    ds_read_b64_tr_b16 v[48:49], v20 offset:36864
    ds_read_b64_tr_b16 v[50:51], v20 offset:37888
    ds_read_b64_tr_b16 v[52:53], v21 offset:36864
    ds_read_b64_tr_b16 v[54:55], v21 offset:37888
    ds_read_b64_tr_b16 v[56:57], v22 offset:36864
    ds_read_b64_tr_b16 v[58:59], v22 offset:37888
    ds_read_b64_tr_b16 v[60:61], v23 offset:36864
    ds_read_b64_tr_b16 v[62:63], v23 offset:37888
    ds_read_b128 v[132:135], v17 offset:0
    s_waitcnt lgkmcnt(9)
    v_mfma_f32_32x32x16_bf16 v[64:79], v[128:131], v[32:35], 0
    ds_read_b64_tr_b16 v[32:33], v20 offset:40960
    ds_read_b64_tr_b16 v[34:35], v20 offset:41984
    v_mfma_f32_32x32x16_bf16 v[80:95], v[128:131], v[36:39], 0
    ds_read_b64_tr_b16 v[36:37], v21 offset:40960
    ds_read_b64_tr_b16 v[38:39], v21 offset:41984
    v_mfma_f32_32x32x16_bf16 v[96:111], v[128:131], v[40:43], 0
    ds_read_b64_tr_b16 v[40:41], v22 offset:40960
    ds_read_b64_tr_b16 v[42:43], v22 offset:41984
    v_mfma_f32_32x32x16_bf16 v[112:127], v[128:131], v[44:47], 0
    ds_read_b64_tr_b16 v[44:45], v23 offset:40960
    ds_read_b64_tr_b16 v[46:47], v23 offset:41984
    ds_read_b128 v[136:139], v18 offset:0
    s_waitcnt lgkmcnt(9)
    v_mfma_f32_32x32x16_bf16 v[64:79], v[132:135], v[48:51], v[64:79]
    ds_read_b64_tr_b16 v[48:49], v20 offset:45056
    ds_read_b64_tr_b16 v[50:51], v20 offset:46080
    v_mfma_f32_32x32x16_bf16 v[80:95], v[132:135], v[52:55], v[80:95]
    ds_read_b64_tr_b16 v[52:53], v21 offset:45056
    ds_read_b64_tr_b16 v[54:55], v21 offset:46080
    v_mfma_f32_32x32x16_bf16 v[96:111], v[132:135], v[56:59], v[96:111]
    ds_read_b64_tr_b16 v[56:57], v22 offset:45056
    ds_read_b64_tr_b16 v[58:59], v22 offset:46080
    v_mfma_f32_32x32x16_bf16 v[112:127], v[132:135], v[60:63], v[112:127]
    ds_read_b64_tr_b16 v[60:61], v23 offset:45056
    ds_read_b64_tr_b16 v[62:63], v23 offset:46080
    ds_read_b128 v[140:143], v19 offset:0
    s_waitcnt lgkmcnt(9)
    v_mfma_f32_32x32x16_bf16 v[64:79], v[136:139], v[32:35], v[64:79]
    s_barrier
    ds_read_b64_tr_b16 v[32:33], v20 offset:49152
    ds_read_b64_tr_b16 v[34:35], v20 offset:50176
    v_mfma_f32_32x32x16_bf16 v[80:95], v[136:139], v[36:39], v[80:95]
    ds_read_b64_tr_b16 v[36:37], v21 offset:49152
    ds_read_b64_tr_b16 v[38:39], v21 offset:50176
    v_mfma_f32_32x32x16_bf16 v[96:111], v[136:139], v[40:43], v[96:111]
    ds_read_b64_tr_b16 v[40:41], v22 offset:49152
    ds_read_b64_tr_b16 v[42:43], v22 offset:50176
    v_mfma_f32_32x32x16_bf16 v[112:127], v[136:139], v[44:47], v[112:127]
    ds_read_b64_tr_b16 v[44:45], v23 offset:49152
    ds_read_b64_tr_b16 v[46:47], v23 offset:50176
    ds_read_b128 v[144:147], v16 offset:16384
    s_waitcnt lgkmcnt(9)
    v_mfma_f32_32x32x16_bf16 v[64:79], v[140:143], v[48:51], v[64:79]
    ds_read_b64_tr_b16 v[48:49], v20 offset:53248
    ds_read_b64_tr_b16 v[50:51], v20 offset:54272
    v_mfma_f32_32x32x16_bf16 v[80:95], v[140:143], v[52:55], v[80:95]
    ds_read_b64_tr_b16 v[52:53], v21 offset:53248
    ds_read_b64_tr_b16 v[54:55], v21 offset:54272
    v_mfma_f32_32x32x16_bf16 v[96:111], v[140:143], v[56:59], v[96:111]
    ds_read_b64_tr_b16 v[56:57], v22 offset:53248
    ds_read_b64_tr_b16 v[58:59], v22 offset:54272
    v_mfma_f32_32x32x16_bf16 v[112:127], v[140:143], v[60:63], v[112:127]
    ds_read_b64_tr_b16 v[60:61], v23 offset:53248
    ds_read_b64_tr_b16 v[62:63], v23 offset:54272
    ds_read_b128 v[148:151], v17 offset:16384
    s_waitcnt lgkmcnt(9)
    v_mfma_f32_32x32x16_bf16 v[64:79], v[144:147], v[32:35], v[64:79]
    ds_read_b64_tr_b16 v[32:33], v20 offset:57344
    ds_read_b64_tr_b16 v[34:35], v20 offset:58368
    v_mfma_f32_32x32x16_bf16 v[80:95], v[144:147], v[36:39], v[80:95]
    ds_read_b64_tr_b16 v[36:37], v21 offset:57344
    ds_read_b64_tr_b16 v[38:39], v21 offset:58368
    v_mfma_f32_32x32x16_bf16 v[96:111], v[144:147], v[40:43], v[96:111]
    ds_read_b64_tr_b16 v[40:41], v22 offset:57344
    ds_read_b64_tr_b16 v[42:43], v22 offset:58368
    v_mfma_f32_32x32x16_bf16 v[112:127], v[144:147], v[44:47], v[112:127]
    ds_read_b64_tr_b16 v[44:45], v23 offset:57344
    ds_read_b64_tr_b16 v[46:47], v23 offset:58368
    ds_read_b128 v[152:155], v18 offset:16384
    s_waitcnt lgkmcnt(9)
    v_mfma_f32_32x32x16_bf16 v[64:79], v[148:151], v[48:51], v[64:79]
    ds_read_b64_tr_b16 v[48:49], v20 offset:61440
    ds_read_b64_tr_b16 v[50:51], v20 offset:62464
    v_mfma_f32_32x32x16_bf16 v[80:95], v[148:151], v[52:55], v[80:95]
    ds_read_b64_tr_b16 v[52:53], v21 offset:61440
    ds_read_b64_tr_b16 v[54:55], v21 offset:62464
    v_mfma_f32_32x32x16_bf16 v[96:111], v[148:151], v[56:59], v[96:111]
    ds_read_b64_tr_b16 v[56:57], v22 offset:61440
    ds_read_b64_tr_b16 v[58:59], v22 offset:62464
    v_mfma_f32_32x32x16_bf16 v[112:127], v[148:151], v[60:63], v[112:127]
    ds_read_b64_tr_b16 v[60:61], v23 offset:61440
    ds_read_b64_tr_b16 v[62:63], v23 offset:62464
    ds_read_b128 v[156:159], v19 offset:16384
    s_waitcnt lgkmcnt(9)
    v_mfma_f32_32x32x16_bf16 v[64:79], v[152:155], v[32:35], v[64:79]
    s_barrier
    ds_read_b64_tr_b16 v[32:33], v20 offset:0
    ds_read_b64_tr_b16 v[34:35], v20 offset:1024
    v_mfma_f32_32x32x16_bf16 v[80:95], v[152:155], v[36:39], v[80:95]
    ds_read_b64_tr_b16 v[36:37], v21 offset:0
    ds_read_b64_tr_b16 v[38:39], v21 offset:1024
    v_mfma_f32_32x32x16_bf16 v[96:111], v[152:155], v[40:43], v[96:111]
    ds_read_b64_tr_b16 v[40:41], v22 offset:0
    ds_read_b64_tr_b16 v[42:43], v22 offset:1024
    v_mfma_f32_32x32x16_bf16 v[112:127], v[152:155], v[44:47], v[112:127]
    ds_read_b64_tr_b16 v[44:45], v23 offset:0
    ds_read_b64_tr_b16 v[46:47], v23 offset:1024
    ds_read_b128 v[160:163], v16 offset:49152
    s_waitcnt lgkmcnt(9)
    v_mfma_f32_32x32x16_bf16 v[64:79], v[156:159], v[48:51], v[64:79]
    ds_read_b64_tr_b16 v[48:49], v20 offset:4096
    ds_read_b64_tr_b16 v[50:51], v20 offset:5120
    v_mfma_f32_32x32x16_bf16 v[80:95], v[156:159], v[52:55], v[80:95]
    ds_read_b64_tr_b16 v[52:53], v21 offset:4096
    ds_read_b64_tr_b16 v[54:55], v21 offset:5120
    v_mfma_f32_32x32x16_bf16 v[96:111], v[156:159], v[56:59], v[96:111]
    ds_read_b64_tr_b16 v[56:57], v22 offset:4096
    ds_read_b64_tr_b16 v[58:59], v22 offset:5120
    v_mfma_f32_32x32x16_bf16 v[112:127], v[156:159], v[60:63], v[112:127]
    ds_read_b64_tr_b16 v[60:61], v23 offset:4096
    ds_read_b64_tr_b16 v[62:63], v23 offset:5120
    ds_read_b128 v[164:167], v17 offset:49152
    s_waitcnt lgkmcnt(9)
    v_mfma_f32_32x32x16_bf16 v[64:79], v[160:163], v[32:35], v[64:79]
    ds_read_b64_tr_b16 v[32:33], v20 offset:8192
    ds_read_b64_tr_b16 v[34:35], v20 offset:9216
    v_mfma_f32_32x32x16_bf16 v[80:95], v[160:163], v[36:39], v[80:95]
    ds_read_b64_tr_b16 v[36:37], v21 offset:8192
    ds_read_b64_tr_b16 v[38:39], v21 offset:9216
    v_mfma_f32_32x32x16_bf16 v[96:111], v[160:163], v[40:43], v[96:111]
    ds_read_b64_tr_b16 v[40:41], v22 offset:8192
    ds_read_b64_tr_b16 v[42:43], v22 offset:9216
    v_mfma_f32_32x32x16_bf16 v[112:127], v[160:163], v[44:47], v[112:127]
    ds_read_b64_tr_b16 v[44:45], v23 offset:8192
    ds_read_b64_tr_b16 v[46:47], v23 offset:9216
    ds_read_b128 v[168:171], v18 offset:49152
    s_waitcnt lgkmcnt(9)
    v_mfma_f32_32x32x16_bf16 v[64:79], v[164:167], v[48:51], v[64:79]
    ds_read_b64_tr_b16 v[48:49], v20 offset:12288
    ds_read_b64_tr_b16 v[50:51], v20 offset:13312
    v_mfma_f32_32x32x16_bf16 v[80:95], v[164:167], v[52:55], v[80:95]
    ds_read_b64_tr_b16 v[52:53], v21 offset:12288
    ds_read_b64_tr_b16 v[54:55], v21 offset:13312
    v_mfma_f32_32x32x16_bf16 v[96:111], v[164:167], v[56:59], v[96:111]
    ds_read_b64_tr_b16 v[56:57], v22 offset:12288
    ds_read_b64_tr_b16 v[58:59], v22 offset:13312
    v_mfma_f32_32x32x16_bf16 v[112:127], v[164:167], v[60:63], v[112:127]
    ds_read_b64_tr_b16 v[60:61], v23 offset:12288
    ds_read_b64_tr_b16 v[62:63], v23 offset:13312
    ds_read_b128 v[172:175], v19 offset:49152
    s_waitcnt lgkmcnt(9)
    v_mfma_f32_32x32x16_bf16 v[64:79], v[168:171], v[32:35], v[64:79]
    s_barrier
    ds_read_b64_tr_b16 v[32:33], v20 offset:16384
    ds_read_b64_tr_b16 v[34:35], v20 offset:17408
    v_mfma_f32_32x32x16_bf16 v[80:95], v[168:171], v[36:39], v[80:95]
    ds_read_b64_tr_b16 v[36:37], v21 offset:16384
    ds_read_b64_tr_b16 v[38:39], v21 offset:17408
    v_mfma_f32_32x32x16_bf16 v[96:111], v[168:171], v[40:43], v[96:111]
    ds_read_b64_tr_b16 v[40:41], v22 offset:16384
    ds_read_b64_tr_b16 v[42:43], v22 offset:17408
    v_mfma_f32_32x32x16_bf16 v[112:127], v[168:171], v[44:47], v[112:127]
    ds_read_b64_tr_b16 v[44:45], v23 offset:16384
    ds_read_b64_tr_b16 v[46:47], v23 offset:17408
    ds_read_b128 v[176:179], v16 offset:32768
    s_waitcnt lgkmcnt(9)
    v_mfma_f32_32x32x16_bf16 v[64:79], v[172:175], v[48:51], v[64:79]
    ds_read_b64_tr_b16 v[48:49], v20 offset:20480
    ds_read_b64_tr_b16 v[50:51], v20 offset:21504
    v_mfma_f32_32x32x16_bf16 v[80:95], v[172:175], v[52:55], v[80:95]
    ds_read_b64_tr_b16 v[52:53], v21 offset:20480
    ds_read_b64_tr_b16 v[54:55], v21 offset:21504
    v_mfma_f32_32x32x16_bf16 v[96:111], v[172:175], v[56:59], v[96:111]
    ds_read_b64_tr_b16 v[56:57], v22 offset:20480
    ds_read_b64_tr_b16 v[58:59], v22 offset:21504
    v_mfma_f32_32x32x16_bf16 v[112:127], v[172:175], v[60:63], v[112:127]
    ds_read_b64_tr_b16 v[60:61], v23 offset:20480
    ds_read_b64_tr_b16 v[62:63], v23 offset:21504
    ds_read_b128 v[180:183], v17 offset:32768
    s_waitcnt lgkmcnt(9)
    v_mfma_f32_32x32x16_bf16 v[64:79], v[176:179], v[32:35], v[64:79]
    ds_read_b64_tr_b16 v[32:33], v20 offset:24576
    ds_read_b64_tr_b16 v[34:35], v20 offset:25600
    v_mfma_f32_32x32x16_bf16 v[80:95], v[176:179], v[36:39], v[80:95]
    ds_read_b64_tr_b16 v[36:37], v21 offset:24576
    ds_read_b64_tr_b16 v[38:39], v21 offset:25600
    v_mfma_f32_32x32x16_bf16 v[96:111], v[176:179], v[40:43], v[96:111]
    ds_read_b64_tr_b16 v[40:41], v22 offset:24576
    ds_read_b64_tr_b16 v[42:43], v22 offset:25600
    v_mfma_f32_32x32x16_bf16 v[112:127], v[176:179], v[44:47], v[112:127]
    ds_read_b64_tr_b16 v[44:45], v23 offset:24576
    ds_read_b64_tr_b16 v[46:47], v23 offset:25600
    ds_read_b128 v[184:187], v18 offset:32768
    s_waitcnt lgkmcnt(9)
    v_mfma_f32_32x32x16_bf16 v[64:79], v[180:183], v[48:51], v[64:79]
    ds_read_b64_tr_b16 v[48:49], v20 offset:28672
    ds_read_b64_tr_b16 v[50:51], v20 offset:29696
    v_mfma_f32_32x32x16_bf16 v[80:95], v[180:183], v[52:55], v[80:95]
    ds_read_b64_tr_b16 v[52:53], v21 offset:28672
    ds_read_b64_tr_b16 v[54:55], v21 offset:29696
    v_mfma_f32_32x32x16_bf16 v[96:111], v[180:183], v[56:59], v[96:111]
    ds_read_b64_tr_b16 v[56:57], v22 offset:28672
    ds_read_b64_tr_b16 v[58:59], v22 offset:29696
    v_mfma_f32_32x32x16_bf16 v[112:127], v[180:183], v[60:63], v[112:127]
    ds_read_b64_tr_b16 v[60:61], v23 offset:28672
    ds_read_b64_tr_b16 v[62:63], v23 offset:29696
    ds_read_b128 v[188:191], v19 offset:32768
    s_waitcnt lgkmcnt(9)
    v_mfma_f32_32x32x16_bf16 v[64:79], v[184:187], v[32:35], v[64:79]
    s_barrier
    ds_read_b64_tr_b16 v[32:33], v20 offset:32768
    ds_read_b64_tr_b16 v[34:35], v20 offset:33792
    v_mfma_f32_32x32x16_bf16 v[80:95], v[184:187], v[36:39], v[80:95]
    ds_read_b64_tr_b16 v[36:37], v21 offset:32768
    ds_read_b64_tr_b16 v[38:39], v21 offset:33792
    v_mfma_f32_32x32x16_bf16 v[96:111], v[184:187], v[40:43], v[96:111]
    ds_read_b64_tr_b16 v[40:41], v22 offset:32768
    ds_read_b64_tr_b16 v[42:43], v22 offset:33792
    v_mfma_f32_32x32x16_bf16 v[112:127], v[184:187], v[44:47], v[112:127]
    ds_read_b64_tr_b16 v[44:45], v23 offset:32768
    ds_read_b64_tr_b16 v[46:47], v23 offset:33792
    ds_read_b128 v[192:195], v16 offset:0
    s_waitcnt lgkmcnt(9)
    v_mfma_f32_32x32x16_bf16 v[64:79], v[188:191], v[48:51], v[64:79]
    ds_read_b64_tr_b16 v[48:49], v20 offset:36864
    ds_read_b64_tr_b16 v[50:51], v20 offset:37888
    v_mfma_f32_32x32x16_bf16 v[80:95], v[188:191], v[52:55], v[80:95]
    ds_read_b64_tr_b16 v[52:53], v21 offset:36864
    ds_read_b64_tr_b16 v[54:55], v21 offset:37888
    v_mfma_f32_32x32x16_bf16 v[96:111], v[188:191], v[56:59], v[96:111]
    ds_read_b64_tr_b16 v[56:57], v22 offset:36864
    ds_read_b64_tr_b16 v[58:59], v22 offset:37888
    v_mfma_f32_32x32x16_bf16 v[112:127], v[188:191], v[60:63], v[112:127]
    ds_read_b64_tr_b16 v[60:61], v23 offset:36864
    ds_read_b64_tr_b16 v[62:63], v23 offset:37888
    ds_read_b128 v[196:199], v17 offset:0
    s_waitcnt lgkmcnt(9)
    v_mfma_f32_32x32x16_bf16 v[64:79], v[192:195], v[32:35], v[64:79]
    ds_read_b64_tr_b16 v[32:33], v20 offset:40960
    ds_read_b64_tr_b16 v[34:35], v20 offset:41984
    v_mfma_f32_32x32x16_bf16 v[80:95], v[192:195], v[36:39], v[80:95]
    ds_read_b64_tr_b16 v[36:37], v21 offset:40960
    ds_read_b64_tr_b16 v[38:39], v21 offset:41984
    v_mfma_f32_32x32x16_bf16 v[96:111], v[192:195], v[40:43], v[96:111]
    ds_read_b64_tr_b16 v[40:41], v22 offset:40960
    ds_read_b64_tr_b16 v[42:43], v22 offset:41984
    v_mfma_f32_32x32x16_bf16 v[112:127], v[192:195], v[44:47], v[112:127]
    ds_read_b64_tr_b16 v[44:45], v23 offset:40960
    ds_read_b64_tr_b16 v[46:47], v23 offset:41984
    ds_read_b128 v[200:203], v18 offset:0
    s_waitcnt lgkmcnt(9)
    v_mfma_f32_32x32x16_bf16 v[64:79], v[196:199], v[48:51], v[64:79]
    ds_read_b64_tr_b16 v[48:49], v20 offset:45056
    ds_read_b64_tr_b16 v[50:51], v20 offset:46080
    v_mfma_f32_32x32x16_bf16 v[80:95], v[196:199], v[52:55], v[80:95]
    ds_read_b64_tr_b16 v[52:53], v21 offset:45056
    ds_read_b64_tr_b16 v[54:55], v21 offset:46080
    v_mfma_f32_32x32x16_bf16 v[96:111], v[196:199], v[56:59], v[96:111]
    ds_read_b64_tr_b16 v[56:57], v22 offset:45056
    ds_read_b64_tr_b16 v[58:59], v22 offset:46080
    v_mfma_f32_32x32x16_bf16 v[112:127], v[196:199], v[60:63], v[112:127]
    ds_read_b64_tr_b16 v[60:61], v23 offset:45056
    ds_read_b64_tr_b16 v[62:63], v23 offset:46080
    ds_read_b128 v[204:207], v19 offset:0
    s_waitcnt lgkmcnt(9)
    v_mfma_f32_32x32x16_bf16 v[64:79], v[200:203], v[32:35], v[64:79]
    s_barrier
    ds_read_b64_tr_b16 v[32:33], v20 offset:49152
    ds_read_b64_tr_b16 v[34:35], v20 offset:50176
    v_mfma_f32_32x32x16_bf16 v[80:95], v[200:203], v[36:39], v[80:95]
    ds_read_b64_tr_b16 v[36:37], v21 offset:49152
    ds_read_b64_tr_b16 v[38:39], v21 offset:50176
    v_mfma_f32_32x32x16_bf16 v[96:111], v[200:203], v[40:43], v[96:111]
    ds_read_b64_tr_b16 v[40:41], v22 offset:49152
    ds_read_b64_tr_b16 v[42:43], v22 offset:50176
    v_mfma_f32_32x32x16_bf16 v[112:127], v[200:203], v[44:47], v[112:127]
    ds_read_b64_tr_b16 v[44:45], v23 offset:49152
    ds_read_b64_tr_b16 v[46:47], v23 offset:50176
    ds_read_b128 v[208:211], v16 offset:16384
    s_waitcnt lgkmcnt(9)
    v_mfma_f32_32x32x16_bf16 v[64:79], v[204:207], v[48:51], v[64:79]
    ds_read_b64_tr_b16 v[48:49], v20 offset:53248
    ds_read_b64_tr_b16 v[50:51], v20 offset:54272
    v_mfma_f32_32x32x16_bf16 v[80:95], v[204:207], v[52:55], v[80:95]
    ds_read_b64_tr_b16 v[52:53], v21 offset:53248
    ds_read_b64_tr_b16 v[54:55], v21 offset:54272
    v_mfma_f32_32x32x16_bf16 v[96:111], v[204:207], v[56:59], v[96:111]
    ds_read_b64_tr_b16 v[56:57], v22 offset:53248
    ds_read_b64_tr_b16 v[58:59], v22 offset:54272
    v_mfma_f32_32x32x16_bf16 v[112:127], v[204:207], v[60:63], v[112:127]
    ds_read_b64_tr_b16 v[60:61], v23 offset:53248
    ds_read_b64_tr_b16 v[62:63], v23 offset:54272
    ds_read_b128 v[212:215], v17 offset:16384
    s_waitcnt lgkmcnt(9)
    v_mfma_f32_32x32x16_bf16 v[64:79], v[208:211], v[32:35], v[64:79]
    ds_read_b64_tr_b16 v[32:33], v20 offset:57344
    ds_read_b64_tr_b16 v[34:35], v20 offset:58368
    v_mfma_f32_32x32x16_bf16 v[80:95], v[208:211], v[36:39], v[80:95]
    ds_read_b64_tr_b16 v[36:37], v21 offset:57344
    ds_read_b64_tr_b16 v[38:39], v21 offset:58368
    v_mfma_f32_32x32x16_bf16 v[96:111], v[208:211], v[40:43], v[96:111]
    ds_read_b64_tr_b16 v[40:41], v22 offset:57344
    ds_read_b64_tr_b16 v[42:43], v22 offset:58368
    v_mfma_f32_32x32x16_bf16 v[112:127], v[208:211], v[44:47], v[112:127]
    ds_read_b64_tr_b16 v[44:45], v23 offset:57344
    ds_read_b64_tr_b16 v[46:47], v23 offset:58368
    ds_read_b128 v[216:219], v18 offset:16384
    s_waitcnt lgkmcnt(9)
    v_mfma_f32_32x32x16_bf16 v[64:79], v[212:215], v[48:51], v[64:79]
    ds_read_b64_tr_b16 v[48:49], v20 offset:61440
    ds_read_b64_tr_b16 v[50:51], v20 offset:62464
    v_mfma_f32_32x32x16_bf16 v[80:95], v[212:215], v[52:55], v[80:95]
    ds_read_b64_tr_b16 v[52:53], v21 offset:61440
    ds_read_b64_tr_b16 v[54:55], v21 offset:62464
    v_mfma_f32_32x32x16_bf16 v[96:111], v[212:215], v[56:59], v[96:111]
    ds_read_b64_tr_b16 v[56:57], v22 offset:61440
    ds_read_b64_tr_b16 v[58:59], v22 offset:62464
    v_mfma_f32_32x32x16_bf16 v[112:127], v[212:215], v[60:63], v[112:127]
    ds_read_b64_tr_b16 v[60:61], v23 offset:61440
    ds_read_b64_tr_b16 v[62:63], v23 offset:62464
    ds_read_b128 v[220:223], v19 offset:16384
    s_waitcnt lgkmcnt(9)
    v_mfma_f32_32x32x16_bf16 v[64:79], v[216:219], v[32:35], v[64:79]
    s_barrier
    ds_read_b64_tr_b16 v[32:33], v20 offset:0
    ds_read_b64_tr_b16 v[34:35], v20 offset:1024
    v_mfma_f32_32x32x16_bf16 v[80:95], v[216:219], v[36:39], v[80:95]
    ds_read_b64_tr_b16 v[36:37], v21 offset:0
    ds_read_b64_tr_b16 v[38:39], v21 offset:1024
    v_mfma_f32_32x32x16_bf16 v[96:111], v[216:219], v[40:43], v[96:111]
    ds_read_b64_tr_b16 v[40:41], v22 offset:0
    ds_read_b64_tr_b16 v[42:43], v22 offset:1024
    v_mfma_f32_32x32x16_bf16 v[112:127], v[216:219], v[44:47], v[112:127]
    ds_read_b64_tr_b16 v[44:45], v23 offset:0
    ds_read_b64_tr_b16 v[46:47], v23 offset:1024
    ds_read_b128 v[224:227], v16 offset:49152
    s_waitcnt lgkmcnt(9)
    v_mfma_f32_32x32x16_bf16 v[64:79], v[220:223], v[48:51], v[64:79]
    ds_read_b64_tr_b16 v[48:49], v20 offset:4096
    ds_read_b64_tr_b16 v[50:51], v20 offset:5120
    v_mfma_f32_32x32x16_bf16 v[80:95], v[220:223], v[52:55], v[80:95]
    ds_read_b64_tr_b16 v[52:53], v21 offset:4096
    ds_read_b64_tr_b16 v[54:55], v21 offset:5120
    v_mfma_f32_32x32x16_bf16 v[96:111], v[220:223], v[56:59], v[96:111]
    ds_read_b64_tr_b16 v[56:57], v22 offset:4096
    ds_read_b64_tr_b16 v[58:59], v22 offset:5120
    v_mfma_f32_32x32x16_bf16 v[112:127], v[220:223], v[60:63], v[112:127]
    ds_read_b64_tr_b16 v[60:61], v23 offset:4096
    ds_read_b64_tr_b16 v[62:63], v23 offset:5120
    ds_read_b128 v[228:231], v17 offset:49152
    s_waitcnt lgkmcnt(9)
    v_mfma_f32_32x32x16_bf16 v[64:79], v[224:227], v[32:35], v[64:79]
    ds_read_b64_tr_b16 v[32:33], v20 offset:8192
    ds_read_b64_tr_b16 v[34:35], v20 offset:9216
    v_mfma_f32_32x32x16_bf16 v[80:95], v[224:227], v[36:39], v[80:95]
    ds_read_b64_tr_b16 v[36:37], v21 offset:8192
    ds_read_b64_tr_b16 v[38:39], v21 offset:9216
    v_mfma_f32_32x32x16_bf16 v[96:111], v[224:227], v[40:43], v[96:111]
    ds_read_b64_tr_b16 v[40:41], v22 offset:8192
    ds_read_b64_tr_b16 v[42:43], v22 offset:9216
    v_mfma_f32_32x32x16_bf16 v[112:127], v[224:227], v[44:47], v[112:127]
    ds_read_b64_tr_b16 v[44:45], v23 offset:8192
    ds_read_b64_tr_b16 v[46:47], v23 offset:9216
    ds_read_b128 v[232:235], v18 offset:49152
    s_waitcnt lgkmcnt(9)
    v_mfma_f32_32x32x16_bf16 v[64:79], v[228:231], v[48:51], v[64:79]
    ds_read_b64_tr_b16 v[48:49], v20 offset:12288
    ds_read_b64_tr_b16 v[50:51], v20 offset:13312
    v_mfma_f32_32x32x16_bf16 v[80:95], v[228:231], v[52:55], v[80:95]
    ds_read_b64_tr_b16 v[52:53], v21 offset:12288
    ds_read_b64_tr_b16 v[54:55], v21 offset:13312
    v_mfma_f32_32x32x16_bf16 v[96:111], v[228:231], v[56:59], v[96:111]
    ds_read_b64_tr_b16 v[56:57], v22 offset:12288
    ds_read_b64_tr_b16 v[58:59], v22 offset:13312
    v_mfma_f32_32x32x16_bf16 v[112:127], v[228:231], v[60:63], v[112:127]
    ds_read_b64_tr_b16 v[60:61], v23 offset:12288
    ds_read_b64_tr_b16 v[62:63], v23 offset:13312
    ds_read_b128 v[236:239], v19 offset:49152
    s_waitcnt lgkmcnt(9)
    v_mfma_f32_32x32x16_bf16 v[64:79], v[232:235], v[32:35], v[64:79]
    s_waitcnt vmcnt(0)
    s_barrier
    ds_read_b64_tr_b16 v[32:33], v20 offset:16384
    ds_read_b64_tr_b16 v[34:35], v20 offset:17408
    v_mfma_f32_32x32x16_bf16 v[80:95], v[232:235], v[36:39], v[80:95]
    ds_read_b64_tr_b16 v[36:37], v21 offset:16384
    ds_read_b64_tr_b16 v[38:39], v21 offset:17408
    v_mfma_f32_32x32x16_bf16 v[96:111], v[232:235], v[40:43], v[96:111]
    ds_read_b64_tr_b16 v[40:41], v22 offset:16384
    ds_read_b64_tr_b16 v[42:43], v22 offset:17408
    v_mfma_f32_32x32x16_bf16 v[112:127], v[232:235], v[44:47], v[112:127]
    ds_read_b64_tr_b16 v[44:45], v23 offset:16384
    ds_read_b64_tr_b16 v[46:47], v23 offset:17408
    ds_read_b128 v[240:243], v16 offset:32768
    s_waitcnt lgkmcnt(9)
    v_mfma_f32_32x32x16_bf16 v[64:79], v[236:239], v[48:51], v[64:79]
    ds_read_b64_tr_b16 v[48:49], v20 offset:20480
    ds_read_b64_tr_b16 v[50:51], v20 offset:21504
    v_mfma_f32_32x32x16_bf16 v[80:95], v[236:239], v[52:55], v[80:95]
    ds_read_b64_tr_b16 v[52:53], v21 offset:20480
    ds_read_b64_tr_b16 v[54:55], v21 offset:21504
    v_mfma_f32_32x32x16_bf16 v[96:111], v[236:239], v[56:59], v[96:111]
    ds_read_b64_tr_b16 v[56:57], v22 offset:20480
    ds_read_b64_tr_b16 v[58:59], v22 offset:21504
    v_mfma_f32_32x32x16_bf16 v[112:127], v[236:239], v[60:63], v[112:127]
    ds_read_b64_tr_b16 v[60:61], v23 offset:20480
    ds_read_b64_tr_b16 v[62:63], v23 offset:21504
    ds_read_b128 v[244:247], v17 offset:32768
    s_waitcnt lgkmcnt(9)
    v_mfma_f32_32x32x16_bf16 v[64:79], v[240:243], v[32:35], v[64:79]
    ds_read_b64_tr_b16 v[32:33], v20 offset:24576
    ds_read_b64_tr_b16 v[34:35], v20 offset:25600
    v_mfma_f32_32x32x16_bf16 v[80:95], v[240:243], v[36:39], v[80:95]
    ds_read_b64_tr_b16 v[36:37], v21 offset:24576
    ds_read_b64_tr_b16 v[38:39], v21 offset:25600
    v_mfma_f32_32x32x16_bf16 v[96:111], v[240:243], v[40:43], v[96:111]
    ds_read_b64_tr_b16 v[40:41], v22 offset:24576
    ds_read_b64_tr_b16 v[42:43], v22 offset:25600
    v_mfma_f32_32x32x16_bf16 v[112:127], v[240:243], v[44:47], v[112:127]
    ds_read_b64_tr_b16 v[44:45], v23 offset:24576
    ds_read_b64_tr_b16 v[46:47], v23 offset:25600
    ds_read_b128 v[248:251], v18 offset:32768
    s_waitcnt lgkmcnt(9)
    v_mfma_f32_32x32x16_bf16 v[64:79], v[244:247], v[48:51], v[64:79]
    ds_read_b64_tr_b16 v[48:49], v20 offset:28672
    ds_read_b64_tr_b16 v[50:51], v20 offset:29696
    v_mfma_f32_32x32x16_bf16 v[80:95], v[244:247], v[52:55], v[80:95]
    ds_read_b64_tr_b16 v[52:53], v21 offset:28672
    ds_read_b64_tr_b16 v[54:55], v21 offset:29696
    v_mfma_f32_32x32x16_bf16 v[96:111], v[244:247], v[56:59], v[96:111]
    ds_read_b64_tr_b16 v[56:57], v22 offset:28672
    ds_read_b64_tr_b16 v[58:59], v22 offset:29696
    v_mfma_f32_32x32x16_bf16 v[112:127], v[244:247], v[60:63], v[112:127]
    ds_read_b64_tr_b16 v[60:61], v23 offset:28672
    ds_read_b64_tr_b16 v[62:63], v23 offset:29696
    ds_read_b128 v[252:255], v19 offset:32768
    s_waitcnt lgkmcnt(9)
    v_mfma_f32_32x32x16_bf16 v[64:79], v[248:251], v[32:35], v[64:79]
    s_barrier
    ds_read_b64_tr_b16 v[32:33], v20 offset:32768
    ds_read_b64_tr_b16 v[34:35], v20 offset:33792
    v_mfma_f32_32x32x16_bf16 v[80:95], v[248:251], v[36:39], v[80:95]
    ds_read_b64_tr_b16 v[36:37], v21 offset:32768
    ds_read_b64_tr_b16 v[38:39], v21 offset:33792
    v_mfma_f32_32x32x16_bf16 v[96:111], v[248:251], v[40:43], v[96:111]
    ds_read_b64_tr_b16 v[40:41], v22 offset:32768
    ds_read_b64_tr_b16 v[42:43], v22 offset:33792
    v_mfma_f32_32x32x16_bf16 v[112:127], v[248:251], v[44:47], v[112:127]
    ds_read_b64_tr_b16 v[44:45], v23 offset:32768
    ds_read_b64_tr_b16 v[46:47], v23 offset:33792
    ds_read_b128 v[24:27], v16 offset:0
    s_waitcnt lgkmcnt(9)
    v_mfma_f32_32x32x16_bf16 v[64:79], v[252:255], v[48:51], v[64:79]
    ds_read_b64_tr_b16 v[48:49], v20 offset:36864
    ds_read_b64_tr_b16 v[50:51], v20 offset:37888
    v_mfma_f32_32x32x16_bf16 v[80:95], v[252:255], v[52:55], v[80:95]
    ds_read_b64_tr_b16 v[52:53], v21 offset:36864
    ds_read_b64_tr_b16 v[54:55], v21 offset:37888
    v_mfma_f32_32x32x16_bf16 v[96:111], v[252:255], v[56:59], v[96:111]
    ds_read_b64_tr_b16 v[56:57], v22 offset:36864
    ds_read_b64_tr_b16 v[58:59], v22 offset:37888
    v_mfma_f32_32x32x16_bf16 v[112:127], v[252:255], v[60:63], v[112:127]
    ds_read_b64_tr_b16 v[60:61], v23 offset:36864
    ds_read_b64_tr_b16 v[62:63], v23 offset:37888
    ds_read_b128 v[28:31], v17 offset:0
    s_waitcnt lgkmcnt(9)
    v_mfma_f32_32x32x16_bf16 v[64:79], v[24:27], v[32:35], v[64:79]
    ds_read_b64_tr_b16 v[32:33], v20 offset:40960
    ds_read_b64_tr_b16 v[34:35], v20 offset:41984
    v_mfma_f32_32x32x16_bf16 v[80:95], v[24:27], v[36:39], v[80:95]
    ds_read_b64_tr_b16 v[36:37], v21 offset:40960
    ds_read_b64_tr_b16 v[38:39], v21 offset:41984
    v_mfma_f32_32x32x16_bf16 v[96:111], v[24:27], v[40:43], v[96:111]
    ds_read_b64_tr_b16 v[40:41], v22 offset:40960
    ds_read_b64_tr_b16 v[42:43], v22 offset:41984
    v_mfma_f32_32x32x16_bf16 v[112:127], v[24:27], v[44:47], v[112:127]
    ds_read_b64_tr_b16 v[44:45], v23 offset:40960
    ds_read_b64_tr_b16 v[46:47], v23 offset:41984
    ds_read_b128 v[24:27], v18 offset:0
    s_waitcnt lgkmcnt(9)
    v_mfma_f32_32x32x16_bf16 v[64:79], v[28:31], v[48:51], v[64:79]
    ds_read_b64_tr_b16 v[48:49], v20 offset:45056
    ds_read_b64_tr_b16 v[50:51], v20 offset:46080
    v_mfma_f32_32x32x16_bf16 v[80:95], v[28:31], v[52:55], v[80:95]
    ds_read_b64_tr_b16 v[52:53], v21 offset:45056
    ds_read_b64_tr_b16 v[54:55], v21 offset:46080
    v_mfma_f32_32x32x16_bf16 v[96:111], v[28:31], v[56:59], v[96:111]
    ds_read_b64_tr_b16 v[56:57], v22 offset:45056
    ds_read_b64_tr_b16 v[58:59], v22 offset:46080
    v_mfma_f32_32x32x16_bf16 v[112:127], v[28:31], v[60:63], v[112:127]
    ds_read_b64_tr_b16 v[60:61], v23 offset:45056
    ds_read_b64_tr_b16 v[62:63], v23 offset:46080
    ds_read_b128 v[28:31], v19 offset:0
    s_waitcnt lgkmcnt(9)
    v_mfma_f32_32x32x16_bf16 v[64:79], v[24:27], v[32:35], v[64:79]
    s_barrier
    ds_read_b64_tr_b16 v[32:33], v20 offset:49152
    ds_read_b64_tr_b16 v[34:35], v20 offset:50176
    v_mfma_f32_32x32x16_bf16 v[80:95], v[24:27], v[36:39], v[80:95]
    ds_read_b64_tr_b16 v[36:37], v21 offset:49152
    ds_read_b64_tr_b16 v[38:39], v21 offset:50176
    v_mfma_f32_32x32x16_bf16 v[96:111], v[24:27], v[40:43], v[96:111]
    ds_read_b64_tr_b16 v[40:41], v22 offset:49152
    ds_read_b64_tr_b16 v[42:43], v22 offset:50176
    v_mfma_f32_32x32x16_bf16 v[112:127], v[24:27], v[44:47], v[112:127]
    ds_read_b64_tr_b16 v[44:45], v23 offset:49152
    ds_read_b64_tr_b16 v[46:47], v23 offset:50176
    ds_read_b128 v[24:27], v16 offset:16384
    s_waitcnt lgkmcnt(9)
    v_mfma_f32_32x32x16_bf16 v[64:79], v[28:31], v[48:51], v[64:79]
    ds_read_b64_tr_b16 v[48:49], v20 offset:53248
    ds_read_b64_tr_b16 v[50:51], v20 offset:54272
    v_mfma_f32_32x32x16_bf16 v[80:95], v[28:31], v[52:55], v[80:95]
    ds_read_b64_tr_b16 v[52:53], v21 offset:53248
    ds_read_b64_tr_b16 v[54:55], v21 offset:54272
    v_mfma_f32_32x32x16_bf16 v[96:111], v[28:31], v[56:59], v[96:111]
    ds_read_b64_tr_b16 v[56:57], v22 offset:53248
    ds_read_b64_tr_b16 v[58:59], v22 offset:54272
    v_mfma_f32_32x32x16_bf16 v[112:127], v[28:31], v[60:63], v[112:127]
    ds_read_b64_tr_b16 v[60:61], v23 offset:53248
    ds_read_b64_tr_b16 v[62:63], v23 offset:54272
    ds_read_b128 v[28:31], v17 offset:16384
    s_waitcnt lgkmcnt(9)
    v_mfma_f32_32x32x16_bf16 v[64:79], v[24:27], v[32:35], v[64:79]
    ds_read_b64_tr_b16 v[32:33], v20 offset:57344
    ds_read_b64_tr_b16 v[34:35], v20 offset:58368
    v_mfma_f32_32x32x16_bf16 v[80:95], v[24:27], v[36:39], v[80:95]
    ds_read_b64_tr_b16 v[36:37], v21 offset:57344
    ds_read_b64_tr_b16 v[38:39], v21 offset:58368
    v_mfma_f32_32x32x16_bf16 v[96:111], v[24:27], v[40:43], v[96:111]
    ds_read_b64_tr_b16 v[40:41], v22 offset:57344
    ds_read_b64_tr_b16 v[42:43], v22 offset:58368
    v_mfma_f32_32x32x16_bf16 v[112:127], v[24:27], v[44:47], v[112:127]
    ds_read_b64_tr_b16 v[44:45], v23 offset:57344
    ds_read_b64_tr_b16 v[46:47], v23 offset:58368
    ds_read_b128 v[24:27], v18 offset:16384
    s_waitcnt lgkmcnt(9)
    v_mfma_f32_32x32x16_bf16 v[64:79], v[28:31], v[48:51], v[64:79]
    ds_read_b64_tr_b16 v[48:49], v20 offset:61440
    ds_read_b64_tr_b16 v[50:51], v20 offset:62464
    v_mfma_f32_32x32x16_bf16 v[80:95], v[28:31], v[52:55], v[80:95]
    ds_read_b64_tr_b16 v[52:53], v21 offset:61440
    ds_read_b64_tr_b16 v[54:55], v21 offset:62464
    v_mfma_f32_32x32x16_bf16 v[96:111], v[28:31], v[56:59], v[96:111]
    ds_read_b64_tr_b16 v[56:57], v22 offset:61440
    ds_read_b64_tr_b16 v[58:59], v22 offset:62464
    v_mfma_f32_32x32x16_bf16 v[112:127], v[28:31], v[60:63], v[112:127]
    ds_read_b64_tr_b16 v[60:61], v23 offset:61440
    ds_read_b64_tr_b16 v[62:63], v23 offset:62464
    ds_read_b128 v[28:31], v19 offset:16384
    s_waitcnt lgkmcnt(9)
    v_mfma_f32_32x32x16_bf16 v[64:79], v[24:27], v[32:35], v[64:79]
    v_mfma_f32_32x32x16_bf16 v[80:95], v[24:27], v[36:39], v[80:95]
    v_mfma_f32_32x32x16_bf16 v[96:111], v[24:27], v[40:43], v[96:111]
    v_mfma_f32_32x32x16_bf16 v[112:127], v[24:27], v[44:47], v[112:127]
    s_waitcnt lgkmcnt(0)
    v_mfma_f32_32x32x16_bf16 v[64:79], v[28:31], v[48:51], v[64:79]
    v_mfma_f32_32x32x16_bf16 v[80:95], v[28:31], v[52:55], v[80:95]
    v_mfma_f32_32x32x16_bf16 v[96:111], v[28:31], v[56:59], v[96:111]
    v_mfma_f32_32x32x16_bf16 v[112:127], v[28:31], v[60:63], v[112:127]
    v_lshlrev_b32 v4, 4, v2
    v_add_u32 v4, 155648, v4
    s_mul_i32 s57, s59, 1280
    s_add_u32 s57, s57, 6291456
    s_nop 4
    v_cvt_pk_bf16_f32 v24, v64, v65
    v_cvt_pk_bf16_f32 v25, v66, v67
    v_cvt_pk_bf16_f32 v26, v68, v69
    v_cvt_pk_bf16_f32 v27, v70, v71
    buffer_store_dwordx4 v[24:27], v8, s[20:23], s57 offen sc1
    v_cvt_pk_bf16_f32 v28, v72, v73
    v_cvt_pk_bf16_f32 v29, v74, v75
    v_cvt_pk_bf16_f32 v30, v76, v77
    v_cvt_pk_bf16_f32 v31, v78, v79
    buffer_store_dwordx4 v[28:31], v9, s[20:23], s57 offen sc1
    v_cvt_pk_bf16_f32 v32, v80, v81
    v_cvt_pk_bf16_f32 v33, v82, v83
    v_cvt_pk_bf16_f32 v34, v84, v85
    v_cvt_pk_bf16_f32 v35, v86, v87
    buffer_store_dwordx4 v[32:35], v10, s[20:23], s57 offen sc1
    v_cvt_pk_bf16_f32 v60, v88, v89
    v_cvt_pk_bf16_f32 v61, v90, v91
    v_cvt_pk_bf16_f32 v62, v92, v93
    v_cvt_pk_bf16_f32 v63, v94, v95
    buffer_store_dwordx4 v[60:63], v11, s[20:23], s57 offen sc1
    v_cvt_pk_bf16_f32 v112, v112, v113
    v_cvt_pk_bf16_f32 v113, v114, v115
    v_cvt_pk_bf16_f32 v114, v116, v117
    v_cvt_pk_bf16_f32 v115, v118, v119
    buffer_store_dwordx4 v[112:115], v14, s[20:23], s57 offen sc1
    v_cvt_pk_bf16_f32 v116, v120, v121
    v_cvt_pk_bf16_f32 v117, v122, v123
    v_cvt_pk_bf16_f32 v118, v124, v125
    v_cvt_pk_bf16_f32 v119, v126, v127
    buffer_store_dwordx4 v[116:119], v15, s[20:23], s57 offen sc1
    v_cvt_pk_bf16_f32 v120, v96, v97
    v_cvt_pk_bf16_f32 v121, v98, v99
    v_cvt_pk_bf16_f32 v122, v100, v101
    v_cvt_pk_bf16_f32 v123, v102, v103
    buffer_store_dwordx4 v[120:123], v12, s[20:23], s57 offen sc1
    v_cvt_pk_bf16_f32 v124, v104, v105
    v_cvt_pk_bf16_f32 v125, v106, v107
    v_cvt_pk_bf16_f32 v126, v108, v109
    v_cvt_pk_bf16_f32 v127, v110, v111
    buffer_store_dwordx4 v[124:127], v13, s[20:23], s57 offen sc1
M_B:
    v_add_u32 v20, 0x10000, v3
    v_add_u32 v21, 0x20000, v3
    v_mov_b32 v5, 156160
    s_lshl_b32 s5, s49, 4
    s_add_u32 s5, s5, s48
    s_lshl_b32 s5, s5, 5
    s_add_u32 s5, s5, s4
    s_lshl_b32 s5, s5, 2
    s_add_u32 s56, s5, 21037056
    s_lshl_b32 s5, s48, 4
    s_add_u32 s5, s5, s49
    s_lshl_b32 s5, s5, 5
    s_add_u32 s5, s5, s4
    s_lshl_b32 s5, s5, 2
    s_add_u32 s24, s5, 21069824
    v_mov_b32 v7, 0
    s_barrier
    ds_read_b32 v6, v5
    ds_read_b128 v[64:67], v4 offset:0
    ds_read_b128 v[68:71], v4 offset:32
    ds_read_b128 v[72:75], v4 offset:64
    ds_read_b128 v[76:79], v4 offset:96
    ds_read_b128 v[80:83], v4 offset:128
    ds_read_b128 v[84:87], v4 offset:160
    ds_read_b128 v[88:91], v4 offset:192
    ds_read_b128 v[92:95], v4 offset:224
    ds_read_b128 v[96:99], v4 offset:256
    ds_read_b128 v[100:103], v4 offset:288
    ds_read_b128 v[104:107], v4 offset:320
    ds_read_b128 v[108:111], v4 offset:352
    ds_read_b64_tr_b16 v[48:49], v21 offset:0
    ds_read_b64_tr_b16 v[50:51], v21 offset:768
    ds_read_b64_tr_b16 v[52:53], v21 offset:64
    ds_read_b64_tr_b16 v[54:55], v21 offset:832
    ds_read_b64_tr_b16 v[56:57], v21 offset:128
    ds_read_b64_tr_b16 v[58:59], v21 offset:896
    ds_read_b64_tr_b16 v[36:37], v21 offset:3072
    ds_read_b64_tr_b16 v[38:39], v21 offset:3840
    ds_read_b64_tr_b16 v[40:41], v21 offset:3136
    ds_read_b64_tr_b16 v[42:43], v21 offset:3904
    ds_read_b64_tr_b16 v[44:45], v21 offset:3200
    ds_read_b64_tr_b16 v[46:47], v21 offset:3968
    s_waitcnt lgkmcnt(6)
    v_mfma_f32_32x32x16_bf16 v[64:79], v[48:51], v[128:131], v[64:79]
    ds_read_b64_tr_b16 v[48:49], v21 offset:6144
    ds_read_b64_tr_b16 v[50:51], v21 offset:6912
    v_mfma_f32_32x32x16_bf16 v[80:95], v[52:55], v[128:131], v[80:95]
    ds_read_b64_tr_b16 v[52:53], v21 offset:6208
    ds_read_b64_tr_b16 v[54:55], v21 offset:6976
    v_mfma_f32_32x32x16_bf16 v[96:111], v[56:59], v[128:131], v[96:111]
    ds_read_b64_tr_b16 v[56:57], v21 offset:6272
    ds_read_b64_tr_b16 v[58:59], v21 offset:7040
    s_waitcnt lgkmcnt(6)
    v_mfma_f32_32x32x16_bf16 v[64:79], v[36:39], v[132:135], v[64:79]
    ds_read_b64_tr_b16 v[36:37], v21 offset:9216
    ds_read_b64_tr_b16 v[38:39], v21 offset:9984
    v_mfma_f32_32x32x16_bf16 v[80:95], v[40:43], v[132:135], v[80:95]
    ds_read_b64_tr_b16 v[40:41], v21 offset:9280
    ds_read_b64_tr_b16 v[42:43], v21 offset:10048
    v_mfma_f32_32x32x16_bf16 v[96:111], v[44:47], v[132:135], v[96:111]
    ds_read_b64_tr_b16 v[44:45], v21 offset:9344
    ds_read_b64_tr_b16 v[46:47], v21 offset:10112
    s_waitcnt lgkmcnt(6)
    v_mfma_f32_32x32x16_bf16 v[64:79], v[48:51], v[136:139], v[64:79]
    ds_read_b64_tr_b16 v[48:49], v21 offset:12288
    ds_read_b64_tr_b16 v[50:51], v21 offset:13056
    v_mfma_f32_32x32x16_bf16 v[80:95], v[52:55], v[136:139], v[80:95]
    ds_read_b64_tr_b16 v[52:53], v21 offset:12352
    ds_read_b64_tr_b16 v[54:55], v21 offset:13120
    v_mfma_f32_32x32x16_bf16 v[96:111], v[56:59], v[136:139], v[96:111]
    ds_read_b64_tr_b16 v[56:57], v21 offset:12416
    ds_read_b64_tr_b16 v[58:59], v21 offset:13184
    s_waitcnt lgkmcnt(6)
    v_mfma_f32_32x32x16_bf16 v[64:79], v[36:39], v[140:143], v[64:79]
    ds_read_b64_tr_b16 v[36:37], v21 offset:15360
    ds_read_b64_tr_b16 v[38:39], v21 offset:16128
    v_mfma_f32_32x32x16_bf16 v[80:95], v[40:43], v[140:143], v[80:95]
    ds_read_b64_tr_b16 v[40:41], v21 offset:15424
    ds_read_b64_tr_b16 v[42:43], v21 offset:16192
    v_mfma_f32_32x32x16_bf16 v[96:111], v[44:47], v[140:143], v[96:111]
    ds_read_b64_tr_b16 v[44:45], v21 offset:15488
    ds_read_b64_tr_b16 v[46:47], v21 offset:16256
    s_waitcnt lgkmcnt(6)
    v_mfma_f32_32x32x16_bf16 v[64:79], v[48:51], v[144:147], v[64:79]
    ds_read_b64_tr_b16 v[48:49], v21 offset:18432
    ds_read_b64_tr_b16 v[50:51], v21 offset:19200
    v_mfma_f32_32x32x16_bf16 v[80:95], v[52:55], v[144:147], v[80:95]
    ds_read_b64_tr_b16 v[52:53], v21 offset:18496
    ds_read_b64_tr_b16 v[54:55], v21 offset:19264
    v_mfma_f32_32x32x16_bf16 v[96:111], v[56:59], v[144:147], v[96:111]
    ds_read_b64_tr_b16 v[56:57], v21 offset:18560
    ds_read_b64_tr_b16 v[58:59], v21 offset:19328
    s_waitcnt lgkmcnt(6)
    v_mfma_f32_32x32x16_bf16 v[64:79], v[36:39], v[148:151], v[64:79]
    ds_read_b64_tr_b16 v[36:37], v21 offset:21504
    ds_read_b64_tr_b16 v[38:39], v21 offset:22272
    v_mfma_f32_32x32x16_bf16 v[80:95], v[40:43], v[148:151], v[80:95]
    ds_read_b64_tr_b16 v[40:41], v21 offset:21568
    ds_read_b64_tr_b16 v[42:43], v21 offset:22336
    v_mfma_f32_32x32x16_bf16 v[96:111], v[44:47], v[148:151], v[96:111]
    ds_read_b64_tr_b16 v[44:45], v21 offset:21632
    ds_read_b64_tr_b16 v[46:47], v21 offset:22400
    s_waitcnt lgkmcnt(6)
    v_mfma_f32_32x32x16_bf16 v[64:79], v[48:51], v[152:155], v[64:79]
    ds_read_b64_tr_b16 v[48:49], v3 offset:57344
    ds_read_b64_tr_b16 v[50:51], v3 offset:58112
    v_mfma_f32_32x32x16_bf16 v[80:95], v[52:55], v[152:155], v[80:95]
    ds_read_b64_tr_b16 v[52:53], v3 offset:57408
    ds_read_b64_tr_b16 v[54:55], v3 offset:58176
    v_mfma_f32_32x32x16_bf16 v[96:111], v[56:59], v[152:155], v[96:111]
    ds_read_b64_tr_b16 v[56:57], v3 offset:57472
    ds_read_b64_tr_b16 v[58:59], v3 offset:58240
    s_waitcnt lgkmcnt(6)
    v_mfma_f32_32x32x16_bf16 v[64:79], v[36:39], v[156:159], v[64:79]
    ds_read_b64_tr_b16 v[36:37], v3 offset:60416
    ds_read_b64_tr_b16 v[38:39], v3 offset:61184
    v_mfma_f32_32x32x16_bf16 v[80:95], v[40:43], v[156:159], v[80:95]
    ds_read_b64_tr_b16 v[40:41], v3 offset:60480
    ds_read_b64_tr_b16 v[42:43], v3 offset:61248
    v_mfma_f32_32x32x16_bf16 v[96:111], v[44:47], v[156:159], v[96:111]
    ds_read_b64_tr_b16 v[44:45], v3 offset:60544
    ds_read_b64_tr_b16 v[46:47], v3 offset:61312
    s_waitcnt lgkmcnt(6)
    v_mfma_f32_32x32x16_bf16 v[64:79], v[48:51], v[160:163], v[64:79]
    s_waitcnt vmcnt(0)
    s_mov_b64 exec, 1
    buffer_store_dword v6, v7, s[20:23], s56 offen sc1
    s_mov_b64 exec, -1
    ds_read_b64_tr_b16 v[48:49], v3 offset:63488
    ds_read_b64_tr_b16 v[50:51], v3 offset:64256
    v_mfma_f32_32x32x16_bf16 v[80:95], v[52:55], v[160:163], v[80:95]
    ds_read_b64_tr_b16 v[52:53], v3 offset:63552
    ds_read_b64_tr_b16 v[54:55], v3 offset:64320
    v_mfma_f32_32x32x16_bf16 v[96:111], v[56:59], v[160:163], v[96:111]
    ds_read_b64_tr_b16 v[56:57], v3 offset:63616
    ds_read_b64_tr_b16 v[58:59], v3 offset:64384
    s_waitcnt lgkmcnt(6)
    v_mfma_f32_32x32x16_bf16 v[64:79], v[36:39], v[164:167], v[64:79]
    ds_read_b64_tr_b16 v[36:37], v20 offset:1024
    ds_read_b64_tr_b16 v[38:39], v20 offset:1792
    v_mfma_f32_32x32x16_bf16 v[80:95], v[40:43], v[164:167], v[80:95]
    ds_read_b64_tr_b16 v[40:41], v20 offset:1088
    ds_read_b64_tr_b16 v[42:43], v20 offset:1856
    v_mfma_f32_32x32x16_bf16 v[96:111], v[44:47], v[164:167], v[96:111]
    ds_read_b64_tr_b16 v[44:45], v20 offset:1152
    ds_read_b64_tr_b16 v[46:47], v20 offset:1920
    s_waitcnt lgkmcnt(6)
    v_mfma_f32_32x32x16_bf16 v[64:79], v[48:51], v[168:171], v[64:79]
    ds_read_b64_tr_b16 v[48:49], v20 offset:4096
    ds_read_b64_tr_b16 v[50:51], v20 offset:4864
    v_mfma_f32_32x32x16_bf16 v[80:95], v[52:55], v[168:171], v[80:95]
    ds_read_b64_tr_b16 v[52:53], v20 offset:4160
    ds_read_b64_tr_b16 v[54:55], v20 offset:4928
    v_mfma_f32_32x32x16_bf16 v[96:111], v[56:59], v[168:171], v[96:111]
    ds_read_b64_tr_b16 v[56:57], v20 offset:4224
    ds_read_b64_tr_b16 v[58:59], v20 offset:4992
    s_waitcnt lgkmcnt(6)
    v_mfma_f32_32x32x16_bf16 v[64:79], v[36:39], v[172:175], v[64:79]
    ds_read_b64_tr_b16 v[36:37], v20 offset:7168
    ds_read_b64_tr_b16 v[38:39], v20 offset:7936
    v_mfma_f32_32x32x16_bf16 v[80:95], v[40:43], v[172:175], v[80:95]
    ds_read_b64_tr_b16 v[40:41], v20 offset:7232
    ds_read_b64_tr_b16 v[42:43], v20 offset:8000
    v_mfma_f32_32x32x16_bf16 v[96:111], v[44:47], v[172:175], v[96:111]
    ds_read_b64_tr_b16 v[44:45], v20 offset:7296
    ds_read_b64_tr_b16 v[46:47], v20 offset:8064
    s_waitcnt lgkmcnt(6)
    v_mfma_f32_32x32x16_bf16 v[64:79], v[48:51], v[176:179], v[64:79]
    ds_read_b64_tr_b16 v[48:49], v20 offset:10240
    ds_read_b64_tr_b16 v[50:51], v20 offset:11008
    v_mfma_f32_32x32x16_bf16 v[80:95], v[52:55], v[176:179], v[80:95]
    ds_read_b64_tr_b16 v[52:53], v20 offset:10304
    ds_read_b64_tr_b16 v[54:55], v20 offset:11072
    v_mfma_f32_32x32x16_bf16 v[96:111], v[56:59], v[176:179], v[96:111]
    ds_read_b64_tr_b16 v[56:57], v20 offset:10368
    ds_read_b64_tr_b16 v[58:59], v20 offset:11136
    s_waitcnt lgkmcnt(6)
    v_mfma_f32_32x32x16_bf16 v[64:79], v[36:39], v[180:183], v[64:79]
    ds_read_b64_tr_b16 v[36:37], v20 offset:13312
    ds_read_b64_tr_b16 v[38:39], v20 offset:14080
    v_mfma_f32_32x32x16_bf16 v[80:95], v[40:43], v[180:183], v[80:95]
    ds_read_b64_tr_b16 v[40:41], v20 offset:13376
    ds_read_b64_tr_b16 v[42:43], v20 offset:14144
    v_mfma_f32_32x32x16_bf16 v[96:111], v[44:47], v[180:183], v[96:111]
    ds_read_b64_tr_b16 v[44:45], v20 offset:13440
    ds_read_b64_tr_b16 v[46:47], v20 offset:14208
    s_waitcnt lgkmcnt(6)
    v_mfma_f32_32x32x16_bf16 v[64:79], v[48:51], v[184:187], v[64:79]
    s_barrier
    ds_read_b64_tr_b16 v[48:49], v3 offset:32768
    ds_read_b64_tr_b16 v[50:51], v3 offset:33536
    v_mov_b32 v12, v6
    v_mov_b32 v13, 0
    s_lshl_b32 s58, s54, 9
    v_mfma_f32_32x32x16_bf16 v[80:95], v[52:55], v[184:187], v[80:95]
    ds_read_b64_tr_b16 v[52:53], v3 offset:32832
    ds_read_b64_tr_b16 v[54:55], v3 offset:33600
    s_lshl_b32 s57, s54, 10
    s_xor_b32 s57, s57, 1024
    s_lshl_b32 s5, s54, 3
    v_mfma_f32_32x32x16_bf16 v[96:111], v[56:59], v[184:187], v[96:111]
    ds_read_b64_tr_b16 v[56:57], v3 offset:32896
    ds_read_b64_tr_b16 v[58:59], v3 offset:33664
    s_add_u32 s57, s57, s5
    v_lshlrev_b32 v32, 2, v2
    v_xor_b32 v32, v32, v1
    s_waitcnt lgkmcnt(6)
    v_mfma_f32_32x32x16_bf16 v[64:79], v[36:39], v[188:191], v[64:79]
    ds_read_b64_tr_b16 v[36:37], v3 offset:35840
    ds_read_b64_tr_b16 v[38:39], v3 offset:36608
    v_lshlrev_b32 v32, 4, v32
    v_lshl_add_u32 v32, v2, 9, v32
    v_add_u32 v32, s58, v32
    v_mfma_f32_32x32x16_bf16 v[80:95], v[40:43], v[188:191], v[80:95]
    ds_read_b64_tr_b16 v[40:41], v3 offset:35904
    ds_read_b64_tr_b16 v[42:43], v3 offset:36672
    v_xor_b32 v33, 8, v1
    v_lshlrev_b32 v33, 4, v33
    v_add_u32 v33, s57, v33
    v_mfma_f32_32x32x16_bf16 v[96:111], v[44:47], v[188:191], v[96:111]
    ds_read_b64_tr_b16 v[44:45], v3 offset:35968
    ds_read_b64_tr_b16 v[46:47], v3 offset:36736
    v_add_u32 v128, 131072, v32
    v_add_u32 v129, 131072, v33
    v_and_b32 v34, 27, v1
    s_waitcnt lgkmcnt(6)
    v_mfma_f32_32x32x16_bf16 v[64:79], v[48:51], v[192:195], v[64:79]
    ds_read_b64_tr_b16 v[48:49], v3 offset:38912
    ds_read_b64_tr_b16 v[50:51], v3 offset:39680
    v_cmp_eq_u32 vcc, 24, v34
    v_min_u32 v35, 21, v1
    v_mul_u32_u24 v34, 352, v2
    v_mfma_f32_32x32x16_bf16 v[80:95], v[52:55], v[192:195], v[80:95]
    ds_read_b64_tr_b16 v[52:53], v3 offset:38976
    ds_read_b64_tr_b16 v[54:55], v3 offset:39744
    v_cndmask_b32 v35, v35, 20, vcc
    v_cmp_eq_u32 vcc, 20, v1
    s_mul_i32 s5, s4, 3072
    v_mfma_f32_32x32x16_bf16 v[96:111], v[56:59], v[192:195], v[96:111]
    ds_read_b64_tr_b16 v[56:57], v3 offset:39040
    ds_read_b64_tr_b16 v[58:59], v3 offset:39808
    s_add_u32 s5, s5, 32768
    v_cndmask_b32 v35, v35, 21, vcc
    v_lshl_add_u32 v35, v35, 4, v34
    s_waitcnt lgkmcnt(6)
    v_mfma_f32_32x32x16_bf16 v[64:79], v[36:39], v[196:199], v[64:79]
    ds_read_b64_tr_b16 v[36:37], v3 offset:41984
    ds_read_b64_tr_b16 v[38:39], v3 offset:42752
    v_add_u32 v130, 131072, v35
    v_add_u32 v131, s5, v32
    v_mul_u32_u24 v34, 1536, v2
    v_mfma_f32_32x32x16_bf16 v[80:95], v[40:43], v[196:199], v[80:95]
    ds_read_b64_tr_b16 v[40:41], v3 offset:42048
    ds_read_b64_tr_b16 v[42:43], v3 offset:42816
    v_add3_u32 v132, v34, s5, v33
    s_lshl_b32 s5, s4, 8
    s_add_u32 s5, s5, 156672
    v_mfma_f32_32x32x16_bf16 v[96:111], v[44:47], v[196:199], v[96:111]
    ds_read_b64_tr_b16 v[44:45], v3 offset:42112
    ds_read_b64_tr_b16 v[46:47], v3 offset:42880
    v_lshl_add_u32 v133, v1, 2, s5
    s_lshl_b32 s62, s51, 2
    s_add_u32 s62, s62, s4
    s_waitcnt lgkmcnt(6)
    v_mfma_f32_32x32x16_bf16 v[64:79], v[48:51], v[200:203], v[64:79]
    ds_read_b64_tr_b16 v[48:49], v3 offset:45056
    ds_read_b64_tr_b16 v[50:51], v3 offset:45824
    s_mul_i32 s5, s62, 81920
    s_add_u32 s5, s5, 17825792
    s_lshl_b32 s6, s50, 10
    v_mfma_f32_32x32x16_bf16 v[80:95], v[52:55], v[200:203], v[80:95]
    ds_read_b64_tr_b16 v[52:53], v3 offset:45120
    ds_read_b64_tr_b16 v[54:55], v3 offset:45888
    s_add_u32 s25, s5, s6
    s_add_u32 s26, s25, 40960
    s_lshl_b32 s6, s50, 8
    v_mfma_f32_32x32x16_bf16 v[96:111], v[56:59], v[200:203], v[96:111]
    ds_read_b64_tr_b16 v[56:57], v3 offset:45184
    ds_read_b64_tr_b16 v[58:59], v3 offset:45952
    s_add_u32 s28, s5, s6
    s_add_u32 s28, s28, 32768
    v_lshlrev_b32 v14, 4, v0
    s_waitcnt lgkmcnt(6)
    v_mfma_f32_32x32x16_bf16 v[64:79], v[36:39], v[204:207], v[64:79]
    ds_read_b64_tr_b16 v[36:37], v3 offset:48128
    ds_read_b64_tr_b16 v[38:39], v3 offset:48896
    v_mul_u32_u24 v15, 40960, v2
    v_lshl_add_u32 v15, v1, 3, v15
    v_mov_b32 v160, 0
    v_mfma_f32_32x32x16_bf16 v[80:95], v[40:43], v[204:207], v[80:95]
    ds_read_b64_tr_b16 v[40:41], v3 offset:48192
    ds_read_b64_tr_b16 v[42:43], v3 offset:48960
    v_mov_b32 v161, 0
    v_mov_b32 v162, 0
    v_mov_b32 v163, 0
    v_mfma_f32_32x32x16_bf16 v[96:111], v[44:47], v[204:207], v[96:111]
    ds_read_b64_tr_b16 v[44:45], v3 offset:48256
    ds_read_b64_tr_b16 v[46:47], v3 offset:49024
    v_mov_b32 v164, 0
    v_mov_b32 v165, 0
    v_mov_b32 v166, 0
    s_waitcnt lgkmcnt(6)
    v_mfma_f32_32x32x16_bf16 v[64:79], v[48:51], v[208:211], v[64:79]
    ds_read_b64_tr_b16 v[48:49], v3 offset:51200
    ds_read_b64_tr_b16 v[50:51], v3 offset:51968
    v_mov_b32 v167, 0
    v_mov_b32 v168, 0
    v_mov_b32 v169, 0
    v_mfma_f32_32x32x16_bf16 v[80:95], v[52:55], v[208:211], v[80:95]
    ds_read_b64_tr_b16 v[52:53], v3 offset:51264
    ds_read_b64_tr_b16 v[54:55], v3 offset:52032
    v_mov_b32 v170, 0
    v_mov_b32 v171, 0
    v_mov_b32 v172, 0
    v_mfma_f32_32x32x16_bf16 v[96:111], v[56:59], v[208:211], v[96:111]
    ds_read_b64_tr_b16 v[56:57], v3 offset:51328
    ds_read_b64_tr_b16 v[58:59], v3 offset:52096
    v_mov_b32 v173, 0
    v_mov_b32 v174, 0
    v_mov_b32 v175, 0
    s_waitcnt lgkmcnt(6)
    v_mfma_f32_32x32x16_bf16 v[64:79], v[36:39], v[212:215], v[64:79]
    ds_read_b64_tr_b16 v[36:37], v3 offset:54272
    ds_read_b64_tr_b16 v[38:39], v3 offset:55040
    v_mov_b32 v176, 0
    v_mov_b32 v177, 0
    v_mov_b32 v178, 0
    v_mfma_f32_32x32x16_bf16 v[80:95], v[40:43], v[212:215], v[80:95]
    ds_read_b64_tr_b16 v[40:41], v3 offset:54336
    ds_read_b64_tr_b16 v[42:43], v3 offset:55104
    v_mov_b32 v179, 0
    v_mov_b32 v180, 0
    v_mov_b32 v181, 0
    v_mfma_f32_32x32x16_bf16 v[96:111], v[44:47], v[212:215], v[96:111]
    ds_read_b64_tr_b16 v[44:45], v3 offset:54400
    ds_read_b64_tr_b16 v[46:47], v3 offset:55168
    v_mov_b32 v182, 0
    v_mov_b32 v183, 0
    v_mov_b32 v184, 0
    s_waitcnt lgkmcnt(6)
    v_mfma_f32_32x32x16_bf16 v[64:79], v[48:51], v[216:219], v[64:79]
    ds_read_b64_tr_b16 v[48:49], v20 offset:16384
    ds_read_b64_tr_b16 v[50:51], v20 offset:17152
    v_mov_b32 v185, 0
    v_mov_b32 v186, 0
    v_mov_b32 v187, 0
    v_mfma_f32_32x32x16_bf16 v[80:95], v[52:55], v[216:219], v[80:95]
    ds_read_b64_tr_b16 v[52:53], v20 offset:16448
    ds_read_b64_tr_b16 v[54:55], v20 offset:17216
    ds_read_b128 v[112:115], v16 offset:0
    v_mov_b32 v188, 0
    v_mov_b32 v189, 0
    v_mov_b32 v190, 0
    v_mfma_f32_32x32x16_bf16 v[96:111], v[56:59], v[216:219], v[96:111]
    ds_read_b64_tr_b16 v[56:57], v20 offset:16512
    ds_read_b64_tr_b16 v[58:59], v20 offset:17280
    ds_read_b128 v[116:119], v17 offset:0
    v_mov_b32 v191, 0
    v_mov_b32 v192, 0
    v_mov_b32 v193, 0
    s_waitcnt lgkmcnt(8)
    v_mfma_f32_32x32x16_bf16 v[64:79], v[36:39], v[220:223], v[64:79]
    ds_read_b64_tr_b16 v[36:37], v20 offset:19456
    ds_read_b64_tr_b16 v[38:39], v20 offset:20224
    v_mov_b32 v194, 0
    v_mov_b32 v195, 0
    v_mov_b32 v196, 0
    v_mfma_f32_32x32x16_bf16 v[80:95], v[40:43], v[220:223], v[80:95]
    ds_read_b64_tr_b16 v[40:41], v20 offset:19520
    ds_read_b64_tr_b16 v[42:43], v20 offset:20288
    ds_read_b128 v[120:123], v18 offset:0
    v_mov_b32 v197, 0
    v_mov_b32 v198, 0
    v_mov_b32 v199, 0
    v_mfma_f32_32x32x16_bf16 v[96:111], v[44:47], v[220:223], v[96:111]
    ds_read_b64_tr_b16 v[44:45], v20 offset:19584
    ds_read_b64_tr_b16 v[46:47], v20 offset:20352
    ds_read_b128 v[124:127], v19 offset:0
    v_mov_b32 v200, 0
    v_mov_b32 v201, 0
    v_mov_b32 v202, 0
    s_waitcnt lgkmcnt(9)
    v_mfma_f32_32x32x16_bf16 v[64:79], v[48:51], v[224:227], v[64:79]
    ds_read_b64_tr_b16 v[48:49], v20 offset:22528
    ds_read_b64_tr_b16 v[50:51], v20 offset:23296
    v_mov_b32 v203, 0
    v_mov_b32 v204, 0
    v_mov_b32 v205, 0
    v_mfma_f32_32x32x16_bf16 v[80:95], v[52:55], v[224:227], v[80:95]
    ds_read_b64_tr_b16 v[52:53], v20 offset:22592
    ds_read_b64_tr_b16 v[54:55], v20 offset:23360
    ds_read_b128 v[24:27], v16 offset:16384
    v_mov_b32 v206, 0
    v_mov_b32 v207, 0
    v_mov_b32 v216, 0
    v_mfma_f32_32x32x16_bf16 v[96:111], v[56:59], v[224:227], v[96:111]
    ds_read_b64_tr_b16 v[56:57], v20 offset:22656
    ds_read_b64_tr_b16 v[58:59], v20 offset:23424
    ds_read_b128 v[28:31], v17 offset:16384
    v_mov_b32 v217, 0
    v_mov_b32 v218, 0
    v_mov_b32 v219, 0
    s_waitcnt lgkmcnt(9)
    v_mfma_f32_32x32x16_bf16 v[64:79], v[36:39], v[228:231], v[64:79]
    ds_read_b64_tr_b16 v[36:37], v20 offset:25600
    ds_read_b64_tr_b16 v[38:39], v20 offset:26368
    v_mov_b32 v220, 0
    v_mov_b32 v221, 0
    v_mov_b32 v222, 0
    v_mfma_f32_32x32x16_bf16 v[80:95], v[40:43], v[228:231], v[80:95]
    ds_read_b64_tr_b16 v[40:41], v20 offset:25664
    ds_read_b64_tr_b16 v[42:43], v20 offset:26432
    ds_read_b128 v[208:211], v18 offset:16384
    v_mov_b32 v223, 0
    v_mfma_f32_32x32x16_bf16 v[96:111], v[44:47], v[228:231], v[96:111]
    ds_read_b64_tr_b16 v[44:45], v20 offset:25728
    ds_read_b64_tr_b16 v[46:47], v20 offset:26496
    ds_read_b128 v[212:215], v19 offset:16384
    s_waitcnt lgkmcnt(9)
    v_mfma_f32_32x32x16_bf16 v[64:79], v[48:51], v[232:235], v[64:79]
    s_barrier
    ds_read_b64_tr_b16 v[48:49], v20 offset:28672
    ds_read_b64_tr_b16 v[50:51], v20 offset:29440
    v_mfma_f32_32x32x16_bf16 v[80:95], v[52:55], v[232:235], v[80:95]
    ds_read_b64_tr_b16 v[52:53], v20 offset:31744
    ds_read_b64_tr_b16 v[54:55], v20 offset:32512
    v_mfma_f32_32x32x16_bf16 v[96:111], v[56:59], v[232:235], v[96:111]
    ds_read_b64_tr_b16 v[56:57], v20 offset:34816
    ds_read_b64_tr_b16 v[58:59], v20 offset:35584
    s_waitcnt lgkmcnt(7)
    v_mfma_f32_32x32x16_bf16 v[64:79], v[36:39], v[236:239], v[64:79]
    ds_read_b64_tr_b16 v[36:37], v20 offset:37888
    ds_read_b64_tr_b16 v[38:39], v20 offset:38656
    v_mfma_f32_32x32x16_bf16 v[80:95], v[40:43], v[236:239], v[80:95]
    ds_read_b64_tr_b16 v[40:41], v20 offset:40960
    ds_read_b64_tr_b16 v[42:43], v20 offset:41728
    v_mfma_f32_32x32x16_bf16 v[96:111], v[44:47], v[236:239], v[96:111]
    ds_read_b64_tr_b16 v[44:45], v20 offset:44032
    ds_read_b64_tr_b16 v[46:47], v20 offset:44800
    s_waitcnt lgkmcnt(8)
    v_mfma_f32_32x32x16_bf16 v[64:79], v[48:51], v[240:243], v[64:79]
    ds_read_b64_tr_b16 v[48:49], v20 offset:47104
    ds_read_b64_tr_b16 v[50:51], v20 offset:47872
    s_mul_i32 s5, s49, 6
    s_mul_i32 s62, s59, 96
    s_add_u32 s62, s62, s5
    s_lshl_b32 s62, s62, 10
    s_add_u32 s62, s62, 10485760
    s_add_u32 s63, s62, 4096
    v_lshlrev_b32 v4, 4, v0
    s_mov_b32 s60, 1069066811
    s_mov_b32 s61, s60
    v_mfma_f32_32x32x16_bf16 v[64:79], v[52:55], v[244:247], v[64:79]
    ds_read_b64_tr_b16 v[52:53], v20 offset:50176
    ds_read_b64_tr_b16 v[54:55], v20 offset:50944
    s_waitcnt lgkmcnt(8)
    v_mfma_f32_32x32x16_bf16 v[64:79], v[56:59], v[248:251], v[64:79]
    ds_read_b64_tr_b16 v[56:57], v20 offset:53248
    ds_read_b64_tr_b16 v[58:59], v20 offset:54016
    v_mfma_f32_32x32x16_bf16 v[64:79], v[36:39], v[252:255], v[64:79]
    ds_read_b64_tr_b16 v[36:37], v20 offset:56320
    ds_read_b64_tr_b16 v[38:39], v20 offset:57088
    s_waitcnt lgkmcnt(8)
    v_mfma_f32_32x32x16_bf16 v[64:79], v[40:43], v[112:115], v[64:79]
    ds_read_b64_tr_b16 v[40:41], v20 offset:59392
    ds_read_b64_tr_b16 v[42:43], v20 offset:60160
    v_mfma_f32_32x32x16_bf16 v[64:79], v[44:47], v[116:119], v[64:79]
    ds_read_b64_tr_b16 v[44:45], v20 offset:62464
    ds_read_b64_tr_b16 v[46:47], v20 offset:63232
    s_waitcnt lgkmcnt(8)
    v_mfma_f32_32x32x16_bf16 v[64:79], v[48:51], v[120:123], v[64:79]
    ds_read_b64_tr_b16 v[48:49], v20 offset:28736
    ds_read_b64_tr_b16 v[50:51], v20 offset:29504
    v_mfma_f32_32x32x16_bf16 v[64:79], v[52:55], v[124:127], v[64:79]
    ds_read_b64_tr_b16 v[52:53], v20 offset:31808
    ds_read_b64_tr_b16 v[54:55], v20 offset:32576
    s_waitcnt lgkmcnt(8)
    v_mfma_f32_32x32x16_bf16 v[64:79], v[56:59], v[24:27], v[64:79]
    ds_read_b64_tr_b16 v[56:57], v20 offset:34880
    ds_read_b64_tr_b16 v[58:59], v20 offset:35648
    v_mfma_f32_32x32x16_bf16 v[64:79], v[36:39], v[28:31], v[64:79]
    ds_read_b64_tr_b16 v[36:37], v20 offset:37952
    ds_read_b64_tr_b16 v[38:39], v20 offset:38720
    s_waitcnt lgkmcnt(8)
    v_mfma_f32_32x32x16_bf16 v[64:79], v[40:43], v[208:211], v[64:79]
    ds_read_b64_tr_b16 v[40:41], v20 offset:41024
    ds_read_b64_tr_b16 v[42:43], v20 offset:41792
    v_mfma_f32_32x32x16_bf16 v[64:79], v[44:47], v[212:215], v[64:79]
    ds_read_b64_tr_b16 v[44:45], v20 offset:44096
    ds_read_b64_tr_b16 v[46:47], v20 offset:44864
    s_waitcnt lgkmcnt(8)
    v_mfma_f32_32x32x16_bf16 v[80:95], v[48:51], v[240:243], v[80:95]
    ds_read_b64_tr_b16 v[48:49], v20 offset:47168
    ds_read_b64_tr_b16 v[50:51], v20 offset:47936
    v_mfma_f32_32x32x16_bf16 v[80:95], v[52:55], v[244:247], v[80:95]
    ds_read_b64_tr_b16 v[52:53], v20 offset:50240
    ds_read_b64_tr_b16 v[54:55], v20 offset:51008
    s_waitcnt lgkmcnt(8)
    v_mfma_f32_32x32x16_bf16 v[80:95], v[56:59], v[248:251], v[80:95]
    ds_read_b64_tr_b16 v[56:57], v20 offset:53312
    ds_read_b64_tr_b16 v[58:59], v20 offset:54080
    v_pk_mul_f32 v[136:137], v[64:65], s[60:61]
    v_pk_mul_f32 v[138:139], v[66:67], s[60:61]
    v_pk_mul_f32 v[140:141], v[68:69], s[60:61]
    v_pk_mul_f32 v[142:143], v[70:71], s[60:61]
    v_exp_f32 v136, v136
    v_exp_f32 v137, v137
    v_exp_f32 v138, v138
    v_mfma_f32_32x32x16_bf16 v[80:95], v[36:39], v[252:255], v[80:95]
    ds_read_b64_tr_b16 v[36:37], v20 offset:56384
    ds_read_b64_tr_b16 v[38:39], v20 offset:57152
    v_exp_f32 v139, v139
    v_exp_f32 v140, v140
    v_exp_f32 v141, v141
    v_exp_f32 v142, v142
    v_exp_f32 v143, v143
    v_pk_fma_f32 v[224:225], v[136:137], 0.5, 1.0 op_sel_hi:[1,0,0]
    v_pk_fma_f32 v[226:227], v[138:139], 0.5, 1.0 op_sel_hi:[1,0,0]
    s_waitcnt lgkmcnt(8)
    v_mfma_f32_32x32x16_bf16 v[80:95], v[40:43], v[112:115], v[80:95]
    ds_read_b64_tr_b16 v[40:41], v20 offset:59456
    ds_read_b64_tr_b16 v[42:43], v20 offset:60224
    v_pk_fma_f32 v[228:229], v[140:141], 0.5, 1.0 op_sel_hi:[1,0,0]
    v_pk_fma_f32 v[230:231], v[142:143], 0.5, 1.0 op_sel_hi:[1,0,0]
    v_pk_fma_f32 v[136:137], v[136:137], v[224:225], 1.0 op_sel_hi:[1,1,0]
    v_pk_fma_f32 v[138:139], v[138:139], v[226:227], 1.0 op_sel_hi:[1,1,0]
    v_pk_fma_f32 v[140:141], v[140:141], v[228:229], 1.0 op_sel_hi:[1,1,0]
    v_pk_fma_f32 v[142:143], v[142:143], v[230:231], 1.0 op_sel_hi:[1,1,0]
    v_rcp_f32 v136, v136
    v_mfma_f32_32x32x16_bf16 v[80:95], v[44:47], v[116:119], v[80:95]
    ds_read_b64_tr_b16 v[44:45], v20 offset:62528
    ds_read_b64_tr_b16 v[46:47], v20 offset:63296
    v_rcp_f32 v137, v137
    v_rcp_f32 v138, v138
    v_rcp_f32 v139, v139
    v_rcp_f32 v140, v140
    v_rcp_f32 v141, v141
    v_rcp_f32 v142, v142
    v_rcp_f32 v143, v143
    s_waitcnt lgkmcnt(8)
    v_mfma_f32_32x32x16_bf16 v[80:95], v[48:51], v[120:123], v[80:95]
    ds_read_b64_tr_b16 v[48:49], v20 offset:28800
    ds_read_b64_tr_b16 v[50:51], v20 offset:29568
    v_pk_fma_f32 v[136:137], v[64:65], v[136:137], v[64:65] neg_lo:[1,0,0] neg_hi:[1,0,0]
    v_pk_fma_f32 v[138:139], v[66:67], v[138:139], v[66:67] neg_lo:[1,0,0] neg_hi:[1,0,0]
    v_pk_fma_f32 v[140:141], v[68:69], v[140:141], v[68:69] neg_lo:[1,0,0] neg_hi:[1,0,0]
    v_pk_fma_f32 v[142:143], v[70:71], v[142:143], v[70:71] neg_lo:[1,0,0] neg_hi:[1,0,0]
    v_cvt_pk_bf16_f32 v144, v136, v137
    v_cvt_pk_bf16_f32 v145, v138, v139
    v_cvt_pk_bf16_f32 v146, v140, v141
    v_mfma_f32_32x32x16_bf16 v[80:95], v[52:55], v[124:127], v[80:95]
    ds_read_b64_tr_b16 v[52:53], v20 offset:31872
    ds_read_b64_tr_b16 v[54:55], v20 offset:32640
    v_cvt_pk_bf16_f32 v147, v142, v143
    buffer_store_dwordx4 v[144:147], v4, s[20:23], s62 offen offset:0 sc1
    v_pk_mul_f32 v[136:137], v[72:73], s[60:61]
    v_pk_mul_f32 v[138:139], v[74:75], s[60:61]
    v_pk_mul_f32 v[140:141], v[76:77], s[60:61]
    v_pk_mul_f32 v[142:143], v[78:79], s[60:61]
    v_exp_f32 v136, v136
    s_waitcnt lgkmcnt(8)
    v_mfma_f32_32x32x16_bf16 v[80:95], v[56:59], v[24:27], v[80:95]
    ds_read_b64_tr_b16 v[56:57], v20 offset:34944
    ds_read_b64_tr_b16 v[58:59], v20 offset:35712
    v_exp_f32 v137, v137
    v_exp_f32 v138, v138
    v_exp_f32 v139, v139
    v_exp_f32 v140, v140
    v_exp_f32 v141, v141
    v_exp_f32 v142, v142
    v_exp_f32 v143, v143
    v_mfma_f32_32x32x16_bf16 v[80:95], v[36:39], v[28:31], v[80:95]
    ds_read_b64_tr_b16 v[36:37], v20 offset:38016
    ds_read_b64_tr_b16 v[38:39], v20 offset:38784
    v_pk_fma_f32 v[224:225], v[136:137], 0.5, 1.0 op_sel_hi:[1,0,0]
    v_pk_fma_f32 v[226:227], v[138:139], 0.5, 1.0 op_sel_hi:[1,0,0]
    v_pk_fma_f32 v[228:229], v[140:141], 0.5, 1.0 op_sel_hi:[1,0,0]
    v_pk_fma_f32 v[230:231], v[142:143], 0.5, 1.0 op_sel_hi:[1,0,0]
    v_pk_fma_f32 v[136:137], v[136:137], v[224:225], 1.0 op_sel_hi:[1,1,0]
    v_pk_fma_f32 v[138:139], v[138:139], v[226:227], 1.0 op_sel_hi:[1,1,0]
    v_pk_fma_f32 v[140:141], v[140:141], v[228:229], 1.0 op_sel_hi:[1,1,0]
    s_waitcnt lgkmcnt(8)
    v_mfma_f32_32x32x16_bf16 v[80:95], v[40:43], v[208:211], v[80:95]
    ds_read_b64_tr_b16 v[40:41], v20 offset:41088
    ds_read_b64_tr_b16 v[42:43], v20 offset:41856
    v_pk_fma_f32 v[142:143], v[142:143], v[230:231], 1.0 op_sel_hi:[1,1,0]
    v_rcp_f32 v136, v136
    v_rcp_f32 v137, v137
    v_rcp_f32 v138, v138
    v_rcp_f32 v139, v139
    v_rcp_f32 v140, v140
    v_rcp_f32 v141, v141
    v_mfma_f32_32x32x16_bf16 v[80:95], v[44:47], v[212:215], v[80:95]
    ds_read_b64_tr_b16 v[44:45], v20 offset:44160
    ds_read_b64_tr_b16 v[46:47], v20 offset:44928
    v_rcp_f32 v142, v142
    v_rcp_f32 v143, v143
    v_pk_fma_f32 v[136:137], v[72:73], v[136:137], v[72:73] neg_lo:[1,0,0] neg_hi:[1,0,0]
    v_pk_fma_f32 v[138:139], v[74:75], v[138:139], v[74:75] neg_lo:[1,0,0] neg_hi:[1,0,0]
    v_pk_fma_f32 v[140:141], v[76:77], v[140:141], v[76:77] neg_lo:[1,0,0] neg_hi:[1,0,0]
    v_pk_fma_f32 v[142:143], v[78:79], v[142:143], v[78:79] neg_lo:[1,0,0] neg_hi:[1,0,0]
    v_cvt_pk_bf16_f32 v148, v136, v137
    s_waitcnt lgkmcnt(8)
    v_mfma_f32_32x32x16_bf16 v[96:111], v[48:51], v[240:243], v[96:111]
    ds_read_b64_tr_b16 v[48:49], v20 offset:47232
    ds_read_b64_tr_b16 v[50:51], v20 offset:48000
    v_cvt_pk_bf16_f32 v149, v138, v139
    v_cvt_pk_bf16_f32 v150, v140, v141
    v_cvt_pk_bf16_f32 v151, v142, v143
    buffer_store_dwordx4 v[148:151], v4, s[20:23], s62 offen offset:1024 sc1
    v_mfma_f32_32x32x16_bf16 v[96:111], v[52:55], v[244:247], v[96:111]
    ds_read_b64_tr_b16 v[52:53], v20 offset:50304
    ds_read_b64_tr_b16 v[54:55], v20 offset:51072
    s_waitcnt lgkmcnt(8)
    v_mfma_f32_32x32x16_bf16 v[96:111], v[56:59], v[248:251], v[96:111]
    ds_read_b64_tr_b16 v[56:57], v20 offset:53376
    ds_read_b64_tr_b16 v[58:59], v20 offset:54144
    v_pk_mul_f32 v[136:137], v[80:81], s[60:61]
    v_pk_mul_f32 v[138:139], v[82:83], s[60:61]
    v_pk_mul_f32 v[140:141], v[84:85], s[60:61]
    v_pk_mul_f32 v[142:143], v[86:87], s[60:61]
    v_exp_f32 v136, v136
    v_exp_f32 v137, v137
    v_exp_f32 v138, v138
    v_mfma_f32_32x32x16_bf16 v[96:111], v[36:39], v[252:255], v[96:111]
    ds_read_b64_tr_b16 v[36:37], v20 offset:56448
    ds_read_b64_tr_b16 v[38:39], v20 offset:57216
    v_exp_f32 v139, v139
    v_exp_f32 v140, v140
    v_exp_f32 v141, v141
    v_exp_f32 v142, v142
    v_exp_f32 v143, v143
    v_pk_fma_f32 v[224:225], v[136:137], 0.5, 1.0 op_sel_hi:[1,0,0]
    v_pk_fma_f32 v[226:227], v[138:139], 0.5, 1.0 op_sel_hi:[1,0,0]
    s_waitcnt lgkmcnt(8)
    v_mfma_f32_32x32x16_bf16 v[96:111], v[40:43], v[112:115], v[96:111]
    ds_read_b64_tr_b16 v[40:41], v20 offset:59520
    ds_read_b64_tr_b16 v[42:43], v20 offset:60288
    v_pk_fma_f32 v[228:229], v[140:141], 0.5, 1.0 op_sel_hi:[1,0,0]
    v_pk_fma_f32 v[230:231], v[142:143], 0.5, 1.0 op_sel_hi:[1,0,0]
    v_pk_fma_f32 v[136:137], v[136:137], v[224:225], 1.0 op_sel_hi:[1,1,0]
    v_pk_fma_f32 v[138:139], v[138:139], v[226:227], 1.0 op_sel_hi:[1,1,0]
    v_pk_fma_f32 v[140:141], v[140:141], v[228:229], 1.0 op_sel_hi:[1,1,0]
    v_pk_fma_f32 v[142:143], v[142:143], v[230:231], 1.0 op_sel_hi:[1,1,0]
    v_rcp_f32 v136, v136
    v_mfma_f32_32x32x16_bf16 v[96:111], v[44:47], v[116:119], v[96:111]
    ds_read_b64_tr_b16 v[44:45], v20 offset:62592
    ds_read_b64_tr_b16 v[46:47], v20 offset:63360
    v_rcp_f32 v137, v137
    v_rcp_f32 v138, v138
    v_rcp_f32 v139, v139
    v_rcp_f32 v140, v140
    v_rcp_f32 v141, v141
    v_rcp_f32 v142, v142
    v_rcp_f32 v143, v143
    s_waitcnt lgkmcnt(8)
    v_mfma_f32_32x32x16_bf16 v[96:111], v[48:51], v[120:123], v[96:111]
    v_pk_fma_f32 v[136:137], v[80:81], v[136:137], v[80:81] neg_lo:[1,0,0] neg_hi:[1,0,0]
    v_pk_fma_f32 v[138:139], v[82:83], v[138:139], v[82:83] neg_lo:[1,0,0] neg_hi:[1,0,0]
    v_pk_fma_f32 v[140:141], v[84:85], v[140:141], v[84:85] neg_lo:[1,0,0] neg_hi:[1,0,0]
    v_pk_fma_f32 v[142:143], v[86:87], v[142:143], v[86:87] neg_lo:[1,0,0] neg_hi:[1,0,0]
    v_cvt_pk_bf16_f32 v152, v136, v137
    v_cvt_pk_bf16_f32 v153, v138, v139
    v_cvt_pk_bf16_f32 v154, v140, v141
    v_mfma_f32_32x32x16_bf16 v[96:111], v[52:55], v[124:127], v[96:111]
    v_cvt_pk_bf16_f32 v155, v142, v143
    buffer_store_dwordx4 v[152:155], v4, s[20:23], s62 offen offset:2048 sc1
    v_pk_mul_f32 v[136:137], v[88:89], s[60:61]
    v_pk_mul_f32 v[138:139], v[90:91], s[60:61]
    v_pk_mul_f32 v[140:141], v[92:93], s[60:61]
    v_pk_mul_f32 v[142:143], v[94:95], s[60:61]
    v_exp_f32 v136, v136
    s_waitcnt lgkmcnt(4)
    v_mfma_f32_32x32x16_bf16 v[96:111], v[56:59], v[24:27], v[96:111]
    v_exp_f32 v137, v137
    v_exp_f32 v138, v138
    v_exp_f32 v139, v139
    v_exp_f32 v140, v140
    v_exp_f32 v141, v141
    v_exp_f32 v142, v142
    v_exp_f32 v143, v143
    v_mfma_f32_32x32x16_bf16 v[96:111], v[36:39], v[28:31], v[96:111]
    v_pk_fma_f32 v[224:225], v[136:137], 0.5, 1.0 op_sel_hi:[1,0,0]
    v_pk_fma_f32 v[226:227], v[138:139], 0.5, 1.0 op_sel_hi:[1,0,0]
    v_pk_fma_f32 v[228:229], v[140:141], 0.5, 1.0 op_sel_hi:[1,0,0]
    v_pk_fma_f32 v[230:231], v[142:143], 0.5, 1.0 op_sel_hi:[1,0,0]
    v_pk_fma_f32 v[136:137], v[136:137], v[224:225], 1.0 op_sel_hi:[1,1,0]
    v_pk_fma_f32 v[138:139], v[138:139], v[226:227], 1.0 op_sel_hi:[1,1,0]
    v_pk_fma_f32 v[140:141], v[140:141], v[228:229], 1.0 op_sel_hi:[1,1,0]
    s_waitcnt lgkmcnt(0)
    v_mfma_f32_32x32x16_bf16 v[96:111], v[40:43], v[208:211], v[96:111]
    v_pk_fma_f32 v[142:143], v[142:143], v[230:231], 1.0 op_sel_hi:[1,1,0]
    v_rcp_f32 v136, v136
    v_rcp_f32 v137, v137
    v_rcp_f32 v138, v138
    v_rcp_f32 v139, v139
    v_rcp_f32 v140, v140
    v_rcp_f32 v141, v141
    v_mfma_f32_32x32x16_bf16 v[96:111], v[44:47], v[212:215], v[96:111]
    v_rcp_f32 v142, v142
    v_rcp_f32 v143, v143
    v_pk_fma_f32 v[136:137], v[88:89], v[136:137], v[88:89] neg_lo:[1,0,0] neg_hi:[1,0,0]
    v_pk_fma_f32 v[138:139], v[90:91], v[138:139], v[90:91] neg_lo:[1,0,0] neg_hi:[1,0,0]
    v_pk_fma_f32 v[140:141], v[92:93], v[140:141], v[92:93] neg_lo:[1,0,0] neg_hi:[1,0,0]
    v_pk_fma_f32 v[142:143], v[94:95], v[142:143], v[94:95] neg_lo:[1,0,0] neg_hi:[1,0,0]
    v_cvt_pk_bf16_f32 v156, v136, v137
    v_cvt_pk_bf16_f32 v157, v138, v139
    v_cvt_pk_bf16_f32 v158, v140, v141
    v_cvt_pk_bf16_f32 v159, v142, v143
    buffer_store_dwordx4 v[156:159], v4, s[20:23], s62 offen offset:3072 sc1
    s_nop 0
    v_pk_mul_f32 v[136:137], v[96:97], s[60:61]
    v_pk_mul_f32 v[138:139], v[98:99], s[60:61]
    v_pk_mul_f32 v[140:141], v[100:101], s[60:61]
    v_pk_mul_f32 v[142:143], v[102:103], s[60:61]
    v_exp_f32 v136, v136
    v_exp_f32 v137, v137
    v_exp_f32 v138, v138
    v_exp_f32 v139, v139
    v_exp_f32 v140, v140
    v_exp_f32 v141, v141
    v_exp_f32 v142, v142
    v_exp_f32 v143, v143
    v_pk_fma_f32 v[224:225], v[136:137], 0.5, 1.0 op_sel_hi:[1,0,0]
    v_pk_fma_f32 v[226:227], v[138:139], 0.5, 1.0 op_sel_hi:[1,0,0]
    v_pk_fma_f32 v[228:229], v[140:141], 0.5, 1.0 op_sel_hi:[1,0,0]
    v_pk_fma_f32 v[230:231], v[142:143], 0.5, 1.0 op_sel_hi:[1,0,0]
    v_pk_fma_f32 v[136:137], v[136:137], v[224:225], 1.0 op_sel_hi:[1,1,0]
    v_pk_fma_f32 v[138:139], v[138:139], v[226:227], 1.0 op_sel_hi:[1,1,0]
    v_pk_fma_f32 v[140:141], v[140:141], v[228:229], 1.0 op_sel_hi:[1,1,0]
    v_pk_fma_f32 v[142:143], v[142:143], v[230:231], 1.0 op_sel_hi:[1,1,0]
    v_rcp_f32 v136, v136
    v_rcp_f32 v137, v137
    v_rcp_f32 v138, v138
    v_rcp_f32 v139, v139
    v_rcp_f32 v140, v140
    v_rcp_f32 v141, v141
    v_rcp_f32 v142, v142
    v_rcp_f32 v143, v143
    v_pk_fma_f32 v[136:137], v[96:97], v[136:137], v[96:97] neg_lo:[1,0,0] neg_hi:[1,0,0]
    v_pk_fma_f32 v[138:139], v[98:99], v[138:139], v[98:99] neg_lo:[1,0,0] neg_hi:[1,0,0]
    v_pk_fma_f32 v[140:141], v[100:101], v[140:141], v[100:101] neg_lo:[1,0,0] neg_hi:[1,0,0]
    v_pk_fma_f32 v[142:143], v[102:103], v[142:143], v[102:103] neg_lo:[1,0,0] neg_hi:[1,0,0]
    v_cvt_pk_bf16_f32 v144, v136, v137
    v_cvt_pk_bf16_f32 v145, v138, v139
    v_cvt_pk_bf16_f32 v146, v140, v141
    v_cvt_pk_bf16_f32 v147, v142, v143
    buffer_store_dwordx4 v[144:147], v4, s[20:23], s63 offen offset:0 sc1
    v_pk_mul_f32 v[136:137], v[104:105], s[60:61]
    v_pk_mul_f32 v[138:139], v[106:107], s[60:61]
    v_pk_mul_f32 v[140:141], v[108:109], s[60:61]
    v_pk_mul_f32 v[142:143], v[110:111], s[60:61]
    v_exp_f32 v136, v136
    v_exp_f32 v137, v137
    v_exp_f32 v138, v138
    v_exp_f32 v139, v139
    v_exp_f32 v140, v140
    v_exp_f32 v141, v141
    v_exp_f32 v142, v142
    v_exp_f32 v143, v143
    v_pk_fma_f32 v[224:225], v[136:137], 0.5, 1.0 op_sel_hi:[1,0,0]
    v_pk_fma_f32 v[226:227], v[138:139], 0.5, 1.0 op_sel_hi:[1,0,0]
    v_pk_fma_f32 v[228:229], v[140:141], 0.5, 1.0 op_sel_hi:[1,0,0]
    v_pk_fma_f32 v[230:231], v[142:143], 0.5, 1.0 op_sel_hi:[1,0,0]
    v_pk_fma_f32 v[136:137], v[136:137], v[224:225], 1.0 op_sel_hi:[1,1,0]
    v_pk_fma_f32 v[138:139], v[138:139], v[226:227], 1.0 op_sel_hi:[1,1,0]
    v_pk_fma_f32 v[140:141], v[140:141], v[228:229], 1.0 op_sel_hi:[1,1,0]
    v_pk_fma_f32 v[142:143], v[142:143], v[230:231], 1.0 op_sel_hi:[1,1,0]
    v_rcp_f32 v136, v136
    v_rcp_f32 v137, v137
    v_rcp_f32 v138, v138
    v_rcp_f32 v139, v139
    v_rcp_f32 v140, v140
    v_rcp_f32 v141, v141
    v_rcp_f32 v142, v142
    v_rcp_f32 v143, v143
    v_pk_fma_f32 v[136:137], v[104:105], v[136:137], v[104:105] neg_lo:[1,0,0] neg_hi:[1,0,0]
    v_pk_fma_f32 v[138:139], v[106:107], v[138:139], v[106:107] neg_lo:[1,0,0] neg_hi:[1,0,0]
    v_pk_fma_f32 v[140:141], v[108:109], v[140:141], v[108:109] neg_lo:[1,0,0] neg_hi:[1,0,0]
    v_pk_fma_f32 v[142:143], v[110:111], v[142:143], v[110:111] neg_lo:[1,0,0] neg_hi:[1,0,0]
    v_cvt_pk_bf16_f32 v148, v136, v137
    v_cvt_pk_bf16_f32 v149, v138, v139
    v_cvt_pk_bf16_f32 v150, v140, v141
    v_cvt_pk_bf16_f32 v151, v142, v143
    buffer_store_dwordx4 v[148:151], v4, s[20:23], s63 offen offset:1024 sc1
    s_barrier
    ds_read_b64 v[24:25], v132
    ds_read2st64_b64 v[212:215], v129 offset0:0 offset1:3
    ds_read_b128 v[16:19], v131
    ds_read_b128 v[208:211], v128
    ds_read_b128 v[20:23], v131 offset:1536
    ds_read_b32 v26, v133
    ds_read_b32 v27, v133 offset:128
    s_waitcnt lgkmcnt(0)
    v_mfma_f32_32x32x4_2b_bf16 v[64:95], v[212:213], v[24:25], 0
    s_nop 15
    s_nop 1
    v_mfma_f32_32x32x16_bf16 v[64:79], v[208:211], v[16:19], v[64:79]
    v_mfma_f32_32x32x16_bf16 v[80:95], v[208:211], v[20:23], v[80:95]
    ds_read_b128 v[208:211], v128 offset:1536
    s_mov_b32 s56, 4294893568
    s_mov_b32 s57, 4294942720
    s_mov_b32 s60, 98304
    s_mov_b32 s61, 0
    s_mov_b32 s63, 0
    s_setprio 1
    s_nop 3
    v_max3_f32 v5, v64, v65, v66
    v_max3_f32 v5, v5, v67, v68
    v_max3_f32 v5, v5, v69, v70
    v_max3_f32 v5, v5, v71, v72
    v_max3_f32 v5, v5, v73, v74
    v_max3_f32 v5, v5, v75, v76
    v_max3_f32 v5, v5, v77, v78
    v_max_f32 v5, v5, v79
    v_max3_f32 v6, v80, v81, v82
    v_max3_f32 v6, v6, v83, v84
    v_max3_f32 v6, v6, v85, v86
    v_max3_f32 v6, v6, v87, v88
    v_max3_f32 v6, v6, v89, v90
    v_max3_f32 v6, v6, v91, v92
    v_max3_f32 v6, v6, v93, v94
    v_max_f32 v6, v6, v95
    v_mov_b32 v7, v5
    v_mov_b32 v31, v6
    s_nop 1
    v_permlane32_swap_b32 v5, v7
    v_permlane32_swap_b32 v6, v31
    v_max_f32 v5, v5, v7
    v_max_f32 v6, v6, v31
    v_pk_mul_f32 v[48:49], v[6:7], -1.0 op_sel_hi:[0,0]
    v_pk_mul_f32 v[32:33], v[4:5], -1.0 op_sel:[1,0] op_sel_hi:[1,0]
    v_pk_mul_f32 v[50:51], v[6:7], -1.0 op_sel_hi:[0,0]
    v_pk_mul_f32 v[34:35], v[4:5], -1.0 op_sel:[1,0] op_sel_hi:[1,0]
    v_pk_mul_f32 v[52:53], v[6:7], -1.0 op_sel_hi:[0,0]
    v_pk_mul_f32 v[36:37], v[4:5], -1.0 op_sel:[1,0] op_sel_hi:[1,0]
    v_pk_mul_f32 v[54:55], v[6:7], -1.0 op_sel_hi:[0,0]
    v_pk_mul_f32 v[38:39], v[4:5], -1.0 op_sel:[1,0] op_sel_hi:[1,0]
    v_pk_mul_f32 v[56:57], v[6:7], -1.0 op_sel_hi:[0,0]
    v_pk_mul_f32 v[40:41], v[4:5], -1.0 op_sel:[1,0] op_sel_hi:[1,0]
    v_pk_mul_f32 v[58:59], v[6:7], -1.0 op_sel_hi:[0,0]
    v_pk_mul_f32 v[42:43], v[4:5], -1.0 op_sel:[1,0] op_sel_hi:[1,0]
    v_pk_mul_f32 v[60:61], v[6:7], -1.0 op_sel_hi:[0,0]
    v_pk_mul_f32 v[44:45], v[4:5], -1.0 op_sel:[1,0] op_sel_hi:[1,0]
    v_pk_mul_f32 v[62:63], v[6:7], -1.0 op_sel_hi:[0,0]
    v_pk_mul_f32 v[46:47], v[4:5], -1.0 op_sel:[1,0] op_sel_hi:[1,0]
    v_pk_add_f32 v[64:65], v[64:65], v[32:33]
    v_pk_add_f32 v[66:67], v[66:67], v[34:35]
    v_pk_add_f32 v[68:69], v[68:69], v[36:37]
    v_pk_add_f32 v[70:71], v[70:71], v[38:39]
    v_pk_add_f32 v[72:73], v[72:73], v[40:41]
    v_pk_add_f32 v[74:75], v[74:75], v[42:43]
    v_pk_add_f32 v[76:77], v[76:77], v[44:45]
    v_pk_add_f32 v[78:79], v[78:79], v[46:47]
    v_pk_add_f32 v[80:81], v[80:81], v[48:49]
    v_pk_add_f32 v[82:83], v[82:83], v[50:51]
    v_pk_add_f32 v[84:85], v[84:85], v[52:53]
    v_pk_add_f32 v[86:87], v[86:87], v[54:55]
    v_pk_add_f32 v[88:89], v[88:89], v[56:57]
    v_pk_add_f32 v[90:91], v[90:91], v[58:59]
    v_pk_add_f32 v[92:93], v[92:93], v[60:61]
    v_pk_add_f32 v[94:95], v[94:95], v[62:63]
.p2align 6
M_LOOP:
    s_waitcnt lgkmcnt(0)
    v_mfma_f32_32x32x4_2b_bf16 v[96:127], v[214:215], v[24:25], v[32:63]
    ds_read2st64_b64 v[212:215], v129 offset0:6 offset1:9
    v_exp_f32 v64, v64
    v_exp_f32 v65, v65
    v_exp_f32 v66, v66
    v_exp_f32 v67, v67
    v_exp_f32 v68, v68
    v_exp_f32 v69, v69
    v_exp_f32 v70, v70
    v_cvt_pk_bf16_f32 v232, v64, v65
    v_mfma_f32_32x32x16_bf16 v[160:175], v[216:219], v[192:195], v[160:175]
    v_exp_f32 v71, v71
    v_exp_f32 v72, v72
    v_exp_f32 v73, v73
    v_mfma_f32_32x32x16_bf16 v[160:175], v[220:223], v[196:199], v[160:175]
    v_exp_f32 v74, v74
    v_exp_f32 v75, v75
    v_exp_f32 v76, v76
    v_mfma_f32_32x32x16_bf16 v[176:191], v[216:219], v[200:203], v[176:191]
    v_exp_f32 v77, v77
    v_exp_f32 v78, v78
    v_exp_f32 v79, v79
    v_mfma_f32_32x32x16_bf16 v[176:191], v[220:223], v[204:207], v[176:191]
    ds_read_b128 v[216:219], v130 offset:12288
    ds_read_b128 v[220:223], v130 offset:12992
    v_exp_f32 v80, v80
    v_exp_f32 v81, v81
    v_mfma_f32_32x32x16_bf16 v[96:111], v[208:211], v[16:19], v[96:111]
    v_exp_f32 v82, v82
    v_exp_f32 v83, v83
    v_exp_f32 v84, v84
    v_mfma_f32_32x32x16_bf16 v[112:127], v[208:211], v[20:23], v[112:127]
    ds_read_b128 v[208:211], v128 offset:3072
    v_cvt_pk_bf16_f32 v233, v66, v67
    v_cvt_pk_bf16_f32 v234, v68, v69
    v_cvt_pk_bf16_f32 v235, v70, v71
    v_cvt_pk_bf16_f32 v236, v72, v73
    v_cvt_pk_bf16_f32 v237, v74, v75
    v_cvt_pk_bf16_f32 v238, v76, v77
    v_cvt_pk_bf16_f32 v239, v78, v79
    v_cvt_pk_bf16_f32 v240, v80, v81
    v_exp_f32 v85, v85
    v_cvt_pk_bf16_f32 v241, v82, v83
    v_exp_f32 v86, v86
    v_cvt_pk_bf16_f32 v242, v84, v85
    v_exp_f32 v87, v87
    v_exp_f32 v88, v88
    v_cvt_pk_bf16_f32 v243, v86, v87
    v_exp_f32 v89, v89
    v_exp_f32 v90, v90
    v_cvt_pk_bf16_f32 v244, v88, v89
    v_exp_f32 v91, v91
    v_exp_f32 v92, v92
    v_cvt_pk_bf16_f32 v245, v90, v91
    v_exp_f32 v93, v93
    v_exp_f32 v94, v94
    v_exp_f32 v95, v95
    v_cvt_pk_bf16_f32 v246, v92, v93
    v_cvt_pk_bf16_f32 v247, v94, v95
    s_waitcnt lgkmcnt(0)
    v_mfma_f32_32x32x4_2b_bf16 v[64:95], v[212:213], v[24:25], v[32:63]
    v_exp_f32 v96, v96
    v_exp_f32 v97, v97
    v_exp_f32 v98, v98
    v_exp_f32 v99, v99
    v_exp_f32 v100, v100
    v_exp_f32 v101, v101
    v_exp_f32 v102, v102
    v_exp_f32 v103, v103
    v_mfma_f32_32x32x16_bf16 v[160:175], v[216:219], v[232:235], v[160:175]
    v_exp_f32 v104, v104
    v_exp_f32 v105, v105
    v_exp_f32 v106, v106
    v_mfma_f32_32x32x16_bf16 v[160:175], v[220:223], v[236:239], v[160:175]
    v_exp_f32 v107, v107
    v_exp_f32 v108, v108
    v_exp_f32 v109, v109
    v_mfma_f32_32x32x16_bf16 v[176:191], v[216:219], v[240:243], v[176:191]
    v_exp_f32 v110, v110
    v_exp_f32 v111, v111
    v_exp_f32 v112, v112
    v_mfma_f32_32x32x16_bf16 v[176:191], v[220:223], v[244:247], v[176:191]
    ds_read_b128 v[216:219], v130 offset:13696
    ds_read_b128 v[220:223], v130 offset:14400
    v_exp_f32 v113, v113
    v_exp_f32 v114, v114
    v_mfma_f32_32x32x16_bf16 v[64:79], v[208:211], v[16:19], v[64:79]
    v_exp_f32 v115, v115
    v_exp_f32 v116, v116
    v_exp_f32 v117, v117
    v_mfma_f32_32x32x16_bf16 v[80:95], v[208:211], v[20:23], v[80:95]
    ds_read_b128 v[208:211], v128 offset:4608
    v_cvt_pk_bf16_f32 v192, v96, v97
    v_cvt_pk_bf16_f32 v193, v98, v99
    v_cvt_pk_bf16_f32 v194, v100, v101
    v_cvt_pk_bf16_f32 v195, v102, v103
    v_cvt_pk_bf16_f32 v196, v104, v105
    v_cvt_pk_bf16_f32 v197, v106, v107
    v_cvt_pk_bf16_f32 v198, v108, v109
    v_cvt_pk_bf16_f32 v199, v110, v111
    v_exp_f32 v118, v118
    v_cvt_pk_bf16_f32 v200, v112, v113
    v_exp_f32 v119, v119
    v_cvt_pk_bf16_f32 v201, v114, v115
    v_exp_f32 v120, v120
    v_cvt_pk_bf16_f32 v202, v116, v117
    v_exp_f32 v121, v121
    v_cvt_pk_bf16_f32 v203, v118, v119
    v_exp_f32 v122, v122
    v_cvt_pk_bf16_f32 v204, v120, v121
    v_exp_f32 v123, v123
    v_exp_f32 v124, v124
    v_cvt_pk_bf16_f32 v205, v122, v123
    v_exp_f32 v125, v125
    v_exp_f32 v126, v126
    v_exp_f32 v127, v127
    v_cvt_pk_bf16_f32 v206, v124, v125
    v_cvt_pk_bf16_f32 v207, v126, v127
    s_waitcnt lgkmcnt(0)
    v_mfma_f32_32x32x4_2b_bf16 v[96:127], v[214:215], v[24:25], v[32:63]
    ds_read2st64_b64 v[212:215], v129 offset0:12 offset1:15
    v_exp_f32 v64, v64
    v_exp_f32 v65, v65
    v_exp_f32 v66, v66
    v_exp_f32 v67, v67
    v_exp_f32 v68, v68
    v_exp_f32 v69, v69
    v_exp_f32 v70, v70
    v_cvt_pk_bf16_f32 v232, v64, v65
    v_mfma_f32_32x32x16_bf16 v[160:175], v[216:219], v[192:195], v[160:175]
    v_exp_f32 v71, v71
    v_exp_f32 v72, v72
    v_exp_f32 v73, v73
    v_mfma_f32_32x32x16_bf16 v[160:175], v[220:223], v[196:199], v[160:175]
    v_exp_f32 v74, v74
    v_exp_f32 v75, v75
    v_exp_f32 v76, v76
    v_mfma_f32_32x32x16_bf16 v[176:191], v[216:219], v[200:203], v[176:191]
    v_exp_f32 v77, v77
    v_exp_f32 v78, v78
    v_exp_f32 v79, v79
    v_mfma_f32_32x32x16_bf16 v[176:191], v[220:223], v[204:207], v[176:191]
    ds_read_b128 v[216:219], v130 offset:15104
    ds_read_b128 v[220:223], v130 offset:15808
    v_exp_f32 v80, v80
    v_exp_f32 v81, v81
    v_mfma_f32_32x32x16_bf16 v[96:111], v[208:211], v[16:19], v[96:111]
    v_exp_f32 v82, v82
    v_exp_f32 v83, v83
    v_exp_f32 v84, v84
    v_mfma_f32_32x32x16_bf16 v[112:127], v[208:211], v[20:23], v[112:127]
    ds_read_b128 v[208:211], v128 offset:6144
    v_cvt_pk_bf16_f32 v233, v66, v67
    v_cvt_pk_bf16_f32 v234, v68, v69
    v_cvt_pk_bf16_f32 v235, v70, v71
    v_cvt_pk_bf16_f32 v236, v72, v73
    v_cvt_pk_bf16_f32 v237, v74, v75
    v_cvt_pk_bf16_f32 v238, v76, v77
    v_cvt_pk_bf16_f32 v239, v78, v79
    v_cvt_pk_bf16_f32 v240, v80, v81
    v_exp_f32 v85, v85
    v_cvt_pk_bf16_f32 v241, v82, v83
    v_exp_f32 v86, v86
    v_cvt_pk_bf16_f32 v242, v84, v85
    v_exp_f32 v87, v87
    v_exp_f32 v88, v88
    v_cvt_pk_bf16_f32 v243, v86, v87
    v_exp_f32 v89, v89
    v_exp_f32 v90, v90
    v_cvt_pk_bf16_f32 v244, v88, v89
    v_exp_f32 v91, v91
    v_exp_f32 v92, v92
    v_cvt_pk_bf16_f32 v245, v90, v91
    v_exp_f32 v93, v93
    v_exp_f32 v94, v94
    v_exp_f32 v95, v95
    v_cvt_pk_bf16_f32 v246, v92, v93
    v_cvt_pk_bf16_f32 v247, v94, v95
    s_waitcnt lgkmcnt(0)
    v_mfma_f32_32x32x4_2b_bf16 v[64:95], v[212:213], v[24:25], v[32:63]
    v_exp_f32 v96, v96
    v_exp_f32 v97, v97
    v_exp_f32 v98, v98
    v_exp_f32 v99, v99
    v_exp_f32 v100, v100
    v_exp_f32 v101, v101
    v_exp_f32 v102, v102
    v_exp_f32 v103, v103
    v_mfma_f32_32x32x16_bf16 v[160:175], v[216:219], v[232:235], v[160:175]
    v_exp_f32 v104, v104
    v_exp_f32 v105, v105
    v_exp_f32 v106, v106
    v_mfma_f32_32x32x16_bf16 v[160:175], v[220:223], v[236:239], v[160:175]
    v_exp_f32 v107, v107
    v_exp_f32 v108, v108
    v_exp_f32 v109, v109
    v_mfma_f32_32x32x16_bf16 v[176:191], v[216:219], v[240:243], v[176:191]
    v_exp_f32 v110, v110
    v_exp_f32 v111, v111
    v_exp_f32 v112, v112
    v_mfma_f32_32x32x16_bf16 v[176:191], v[220:223], v[244:247], v[176:191]
    ds_read_b128 v[216:219], v130 offset:16512
    ds_read_b128 v[220:223], v130 offset:17216
    v_exp_f32 v113, v113
    v_exp_f32 v114, v114
    v_mfma_f32_32x32x16_bf16 v[64:79], v[208:211], v[16:19], v[64:79]
    v_exp_f32 v115, v115
    v_exp_f32 v116, v116
    v_exp_f32 v117, v117
    v_mfma_f32_32x32x16_bf16 v[80:95], v[208:211], v[20:23], v[80:95]
    ds_read_b128 v[208:211], v128 offset:7680
    v_cvt_pk_bf16_f32 v192, v96, v97
    v_cvt_pk_bf16_f32 v193, v98, v99
    v_cvt_pk_bf16_f32 v194, v100, v101
    v_cvt_pk_bf16_f32 v195, v102, v103
    v_cvt_pk_bf16_f32 v196, v104, v105
    v_cvt_pk_bf16_f32 v197, v106, v107
    v_cvt_pk_bf16_f32 v198, v108, v109
    v_cvt_pk_bf16_f32 v199, v110, v111
    v_exp_f32 v118, v118
    v_cvt_pk_bf16_f32 v200, v112, v113
    v_exp_f32 v119, v119
    v_cvt_pk_bf16_f32 v201, v114, v115
    v_exp_f32 v120, v120
    v_cvt_pk_bf16_f32 v202, v116, v117
    v_exp_f32 v121, v121
    v_cvt_pk_bf16_f32 v203, v118, v119
    v_exp_f32 v122, v122
    v_cvt_pk_bf16_f32 v204, v120, v121
    v_exp_f32 v123, v123
    v_exp_f32 v124, v124
    v_cvt_pk_bf16_f32 v205, v122, v123
    v_exp_f32 v125, v125
    v_exp_f32 v126, v126
    v_exp_f32 v127, v127
    v_cvt_pk_bf16_f32 v206, v124, v125
    v_cvt_pk_bf16_f32 v207, v126, v127
    s_waitcnt lgkmcnt(0)
    v_mfma_f32_32x32x4_2b_bf16 v[96:127], v[214:215], v[24:25], v[32:63]
    ds_read2st64_b64 v[212:215], v129 offset0:18 offset1:21
    v_exp_f32 v64, v64
    v_exp_f32 v65, v65
    v_exp_f32 v66, v66
    v_exp_f32 v67, v67
    v_exp_f32 v68, v68
    v_exp_f32 v69, v69
    v_exp_f32 v70, v70
    v_cvt_pk_bf16_f32 v232, v64, v65
    v_mfma_f32_32x32x16_bf16 v[160:175], v[216:219], v[192:195], v[160:175]
    v_exp_f32 v71, v71
    v_exp_f32 v72, v72
    v_exp_f32 v73, v73
    v_mfma_f32_32x32x16_bf16 v[160:175], v[220:223], v[196:199], v[160:175]
    v_exp_f32 v74, v74
    v_exp_f32 v75, v75
    v_exp_f32 v76, v76
    v_mfma_f32_32x32x16_bf16 v[176:191], v[216:219], v[200:203], v[176:191]
    v_exp_f32 v77, v77
    v_exp_f32 v78, v78
    v_exp_f32 v79, v79
    v_mfma_f32_32x32x16_bf16 v[176:191], v[220:223], v[204:207], v[176:191]
    ds_read_b128 v[216:219], v130 offset:17920
    ds_read_b128 v[220:223], v130 offset:18624
    v_exp_f32 v80, v80
    v_exp_f32 v81, v81
    v_mfma_f32_32x32x16_bf16 v[96:111], v[208:211], v[16:19], v[96:111]
    v_exp_f32 v82, v82
    v_exp_f32 v83, v83
    v_exp_f32 v84, v84
    v_mfma_f32_32x32x16_bf16 v[112:127], v[208:211], v[20:23], v[112:127]
    ds_read_b128 v[208:211], v128 offset:9216
    s_cmp_eq_u32 s61, 0
    s_cbranch_scc1 M_SIDE
M_SIDEBACK:
    v_cvt_pk_bf16_f32 v233, v66, v67
    v_cvt_pk_bf16_f32 v234, v68, v69
    v_cvt_pk_bf16_f32 v235, v70, v71
    v_cvt_pk_bf16_f32 v236, v72, v73
    v_cvt_pk_bf16_f32 v237, v74, v75
    v_cvt_pk_bf16_f32 v238, v76, v77
    v_cvt_pk_bf16_f32 v239, v78, v79
    v_cvt_pk_bf16_f32 v240, v80, v81
    v_exp_f32 v85, v85
    v_cvt_pk_bf16_f32 v241, v82, v83
    v_exp_f32 v86, v86
    v_cvt_pk_bf16_f32 v242, v84, v85
    v_exp_f32 v87, v87
    v_exp_f32 v88, v88
    v_cvt_pk_bf16_f32 v243, v86, v87
    v_exp_f32 v89, v89
    v_exp_f32 v90, v90
    v_cvt_pk_bf16_f32 v244, v88, v89
    v_exp_f32 v91, v91
    v_exp_f32 v92, v92
    v_cvt_pk_bf16_f32 v245, v90, v91
    v_exp_f32 v93, v93
    v_exp_f32 v94, v94
    v_exp_f32 v95, v95
    v_cvt_pk_bf16_f32 v246, v92, v93
    v_cvt_pk_bf16_f32 v247, v94, v95
    s_waitcnt lgkmcnt(0)
    v_mfma_f32_32x32x4_2b_bf16 v[64:95], v[212:213], v[24:25], v[32:63]
    v_exp_f32 v96, v96
    v_exp_f32 v97, v97
    v_exp_f32 v98, v98
    v_exp_f32 v99, v99
    v_exp_f32 v100, v100
    v_exp_f32 v101, v101
    v_exp_f32 v102, v102
    v_exp_f32 v103, v103
    v_mfma_f32_32x32x16_bf16 v[160:175], v[216:219], v[232:235], v[160:175]
    v_exp_f32 v104, v104
    v_exp_f32 v105, v105
    v_exp_f32 v106, v106
    v_mfma_f32_32x32x16_bf16 v[160:175], v[220:223], v[236:239], v[160:175]
    v_exp_f32 v107, v107
    v_exp_f32 v108, v108
    v_exp_f32 v109, v109
    v_mfma_f32_32x32x16_bf16 v[176:191], v[216:219], v[240:243], v[176:191]
    v_exp_f32 v110, v110
    v_exp_f32 v111, v111
    v_exp_f32 v112, v112
    v_mfma_f32_32x32x16_bf16 v[176:191], v[220:223], v[244:247], v[176:191]
    ds_read_b128 v[216:219], v130 offset:19328
    ds_read_b128 v[220:223], v130 offset:20032
    v_exp_f32 v113, v113
    v_exp_f32 v114, v114
    v_mfma_f32_32x32x16_bf16 v[64:79], v[208:211], v[16:19], v[64:79]
    v_exp_f32 v115, v115
    v_exp_f32 v116, v116
    v_exp_f32 v117, v117
    v_mfma_f32_32x32x16_bf16 v[80:95], v[208:211], v[20:23], v[80:95]
    ds_read_b128 v[208:211], v128 offset:10752
    v_add_u32 v129, s56, v129
    v_add_u32 v128, s56, v128
    s_barrier
    v_cvt_pk_bf16_f32 v192, v96, v97
    v_cvt_pk_bf16_f32 v193, v98, v99
    v_cvt_pk_bf16_f32 v194, v100, v101
    v_cvt_pk_bf16_f32 v195, v102, v103
    v_cvt_pk_bf16_f32 v196, v104, v105
    v_cvt_pk_bf16_f32 v197, v106, v107
    v_cvt_pk_bf16_f32 v198, v108, v109
    v_cvt_pk_bf16_f32 v199, v110, v111
    v_exp_f32 v118, v118
    v_cvt_pk_bf16_f32 v200, v112, v113
    v_exp_f32 v119, v119
    v_cvt_pk_bf16_f32 v201, v114, v115
    v_exp_f32 v120, v120
    v_cvt_pk_bf16_f32 v202, v116, v117
    v_exp_f32 v121, v121
    v_cvt_pk_bf16_f32 v203, v118, v119
    v_exp_f32 v122, v122
    v_cvt_pk_bf16_f32 v204, v120, v121
    v_exp_f32 v123, v123
    v_exp_f32 v124, v124
    v_cvt_pk_bf16_f32 v205, v122, v123
    v_exp_f32 v125, v125
    v_exp_f32 v126, v126
    v_exp_f32 v127, v127
    v_cvt_pk_bf16_f32 v206, v124, v125
    v_cvt_pk_bf16_f32 v207, v126, v127
    s_waitcnt lgkmcnt(0)
    v_mfma_f32_32x32x4_2b_bf16 v[96:127], v[214:215], v[24:25], v[32:63]
    ds_read2st64_b64 v[212:215], v129 offset0:0 offset1:3
    v_exp_f32 v64, v64
    v_exp_f32 v65, v65
    v_exp_f32 v66, v66
    v_exp_f32 v67, v67
    v_exp_f32 v68, v68
    v_exp_f32 v69, v69
    v_exp_f32 v70, v70
    v_cvt_pk_bf16_f32 v232, v64, v65
    v_mfma_f32_32x32x16_bf16 v[160:175], v[216:219], v[192:195], v[160:175]
    v_exp_f32 v71, v71
    v_exp_f32 v72, v72
    v_exp_f32 v73, v73
    v_mfma_f32_32x32x16_bf16 v[160:175], v[220:223], v[196:199], v[160:175]
    v_exp_f32 v74, v74
    v_exp_f32 v75, v75
    v_exp_f32 v76, v76
    v_mfma_f32_32x32x16_bf16 v[176:191], v[216:219], v[200:203], v[176:191]
    v_exp_f32 v77, v77
    v_exp_f32 v78, v78
    v_exp_f32 v79, v79
    v_mfma_f32_32x32x16_bf16 v[176:191], v[220:223], v[204:207], v[176:191]
    ds_read_b128 v[216:219], v130 offset:20736
    ds_read_b128 v[220:223], v130 offset:21440
    v_exp_f32 v80, v80
    v_exp_f32 v81, v81
    v_mfma_f32_32x32x16_bf16 v[96:111], v[208:211], v[16:19], v[96:111]
    v_exp_f32 v82, v82
    v_exp_f32 v83, v83
    v_exp_f32 v84, v84
    v_mfma_f32_32x32x16_bf16 v[112:127], v[208:211], v[20:23], v[112:127]
    ds_read_b128 v[208:211], v128 offset:0
    v_cvt_pk_bf16_f32 v233, v66, v67
    v_cvt_pk_bf16_f32 v234, v68, v69
    v_cvt_pk_bf16_f32 v235, v70, v71
    v_cvt_pk_bf16_f32 v236, v72, v73
    v_cvt_pk_bf16_f32 v237, v74, v75
    v_cvt_pk_bf16_f32 v238, v76, v77
    v_cvt_pk_bf16_f32 v239, v78, v79
    v_cvt_pk_bf16_f32 v240, v80, v81
    v_exp_f32 v85, v85
    v_cvt_pk_bf16_f32 v241, v82, v83
    v_exp_f32 v86, v86
    v_cvt_pk_bf16_f32 v242, v84, v85
    v_exp_f32 v87, v87
    v_exp_f32 v88, v88
    v_cvt_pk_bf16_f32 v243, v86, v87
    v_exp_f32 v89, v89
    v_exp_f32 v90, v90
    v_cvt_pk_bf16_f32 v244, v88, v89
    v_exp_f32 v91, v91
    v_exp_f32 v92, v92
    v_cvt_pk_bf16_f32 v245, v90, v91
    v_exp_f32 v93, v93
    v_exp_f32 v94, v94
    v_exp_f32 v95, v95
    v_cvt_pk_bf16_f32 v246, v92, v93
    v_cvt_pk_bf16_f32 v247, v94, v95
    s_waitcnt lgkmcnt(0)
    v_mfma_f32_32x32x4_2b_bf16 v[64:95], v[212:213], v[24:25], v[32:63]
    v_exp_f32 v96, v96
    v_exp_f32 v97, v97
    v_exp_f32 v98, v98
    v_exp_f32 v99, v99
    v_exp_f32 v100, v100
    v_exp_f32 v101, v101
    v_exp_f32 v102, v102
    v_exp_f32 v103, v103
    v_mfma_f32_32x32x16_bf16 v[160:175], v[216:219], v[232:235], v[160:175]
    v_exp_f32 v104, v104
    v_exp_f32 v105, v105
    v_exp_f32 v106, v106
    v_mfma_f32_32x32x16_bf16 v[160:175], v[220:223], v[236:239], v[160:175]
    v_exp_f32 v107, v107
    v_exp_f32 v108, v108
    v_exp_f32 v109, v109
    v_mfma_f32_32x32x16_bf16 v[176:191], v[216:219], v[240:243], v[176:191]
    v_exp_f32 v110, v110
    v_exp_f32 v111, v111
    v_exp_f32 v112, v112
    v_mfma_f32_32x32x16_bf16 v[176:191], v[220:223], v[244:247], v[176:191]
    ds_read_b128 v[216:219], v130 offset:22144
    ds_read_b128 v[220:223], v130 offset:22848
    v_exp_f32 v113, v113
    v_exp_f32 v114, v114
    v_mfma_f32_32x32x16_bf16 v[64:79], v[208:211], v[16:19], v[64:79]
    v_exp_f32 v115, v115
    v_exp_f32 v116, v116
    v_exp_f32 v117, v117
    v_mfma_f32_32x32x16_bf16 v[80:95], v[208:211], v[20:23], v[80:95]
    ds_read_b128 v[208:211], v128 offset:1536
    v_add_u32 v130, s56, v130
    s_mov_b32 s62, s56
    s_mov_b32 s56, s57
    s_mov_b32 s57, s60
    s_mov_b32 s60, s62
    s_add_u32 s61, s61, 1
    s_cmp_lt_u32 s61, 8
    v_cvt_pk_bf16_f32 v192, v96, v97
    v_cvt_pk_bf16_f32 v193, v98, v99
    v_cvt_pk_bf16_f32 v194, v100, v101
    v_cvt_pk_bf16_f32 v195, v102, v103
    v_cvt_pk_bf16_f32 v196, v104, v105
    v_cvt_pk_bf16_f32 v197, v106, v107
    v_cvt_pk_bf16_f32 v198, v108, v109
    v_cvt_pk_bf16_f32 v199, v110, v111
    v_exp_f32 v118, v118
    v_cvt_pk_bf16_f32 v200, v112, v113
    v_exp_f32 v119, v119
    v_cvt_pk_bf16_f32 v201, v114, v115
    v_exp_f32 v120, v120
    v_cvt_pk_bf16_f32 v202, v116, v117
    v_exp_f32 v121, v121
    v_cvt_pk_bf16_f32 v203, v118, v119
    v_exp_f32 v122, v122
    v_cvt_pk_bf16_f32 v204, v120, v121
    v_exp_f32 v123, v123
    v_exp_f32 v124, v124
    v_cvt_pk_bf16_f32 v205, v122, v123
    v_exp_f32 v125, v125
    v_exp_f32 v126, v126
    v_exp_f32 v127, v127
    v_cvt_pk_bf16_f32 v206, v124, v125
    v_cvt_pk_bf16_f32 v207, v126, v127
    s_cbranch_scc1 M_LOOP
    s_waitcnt lgkmcnt(0)
    v_mfma_f32_32x32x16_bf16 v[160:175], v[216:219], v[192:195], v[160:175]
    v_mfma_f32_32x32x16_bf16 v[176:191], v[216:219], v[200:203], v[176:191]
    v_mfma_f32_32x32x16_bf16 v[160:175], v[220:223], v[196:199], v[160:175]
    v_mfma_f32_32x32x16_bf16 v[176:191], v[220:223], v[204:207], v[176:191]
M_EPI:
    s_mov_b32 s60, 1400897536
    s_nop 9
    v_rcp_f32 v3, v172
    v_cmp_gt_f32 vcc, s60, v172
    v_rcp_f32 v4, v188
    v_cmp_gt_f32 s[58:59], s60, v188
    v_mul_f32 v6, v3, v26
    v_mul_f32 v8, v4, v27
    s_and_b64 s[58:59], s[58:59], vcc
    s_cmp_eq_u64 s[58:59], -1
    s_cselect_b32 s5, 1, s63
    s_cmp_eq_u32 s5, 0
    s_cbranch_scc1 M_REDO
    v_pk_mul_f32 v[160:161], v[160:161], v[6:7] op_sel_hi:[1,0]
    v_pk_mul_f32 v[162:163], v[162:163], v[6:7] op_sel_hi:[1,0]
    v_pk_mul_f32 v[164:165], v[164:165], v[6:7] op_sel_hi:[1,0]
    v_pk_mul_f32 v[166:167], v[166:167], v[6:7] op_sel_hi:[1,0]
    v_pk_mul_f32 v[168:169], v[168:169], v[6:7] op_sel_hi:[1,0]
    v_pk_mul_f32 v[170:171], v[170:171], v[6:7] op_sel_hi:[1,0]
    v_cvt_pk_bf16_f32 v232, v160, v161
    v_cvt_pk_bf16_f32 v233, v162, v163
    v_cvt_pk_bf16_f32 v234, v164, v165
    v_cvt_pk_bf16_f32 v235, v166, v167
    v_cvt_pk_bf16_f32 v236, v168, v169
    v_cvt_pk_bf16_f32 v237, v170, v171
    buffer_store_dwordx4 v[232:235], v14, s[20:23], s25 offen sc1
    v_pk_mul_f32 v[176:177], v[176:177], v[8:9] op_sel_hi:[1,0]
    v_pk_mul_f32 v[178:179], v[178:179], v[8:9] op_sel_hi:[1,0]
    v_pk_mul_f32 v[180:181], v[180:181], v[8:9] op_sel_hi:[1,0]
    v_pk_mul_f32 v[182:183], v[182:183], v[8:9] op_sel_hi:[1,0]
    v_pk_mul_f32 v[184:185], v[184:185], v[8:9] op_sel_hi:[1,0]
    v_pk_mul_f32 v[186:187], v[186:187], v[8:9] op_sel_hi:[1,0]
    v_cvt_pk_bf16_f32 v240, v176, v177
    v_cvt_pk_bf16_f32 v241, v178, v179
    v_cvt_pk_bf16_f32 v242, v180, v181
    v_cvt_pk_bf16_f32 v243, v182, v183
    v_cvt_pk_bf16_f32 v244, v184, v185
    v_cvt_pk_bf16_f32 v245, v186, v187
    buffer_store_dwordx4 v[240:243], v14, s[20:23], s26 offen sc1
    v_permlane32_swap_b32 v236, v244
    v_permlane32_swap_b32 v237, v245
    buffer_store_dwordx2 v[236:237], v15, s[20:23], s28 offen sc1
    s_barrier
    s_branch L_END
M_SIDE:
    s_waitcnt vmcnt(0)
    s_mov_b64 exec, 1
    buffer_store_dword v12, v13, s[20:23], s24 offen sc1
    s_mov_b64 exec, -1
    s_branch M_SIDEBACK
M_REDO:
    s_lshl_b32 s58, s54, 9
    s_lshl_b32 s59, s54, 10
    s_xor_b32 s59, s59, 1024
    s_lshl_b32 s5, s54, 3
    s_add_u32 s59, s59, s5
    v_lshlrev_b32 v3, 2, v2
    v_xor_b32 v3, v3, v1
    v_lshlrev_b32 v3, 4, v3
    v_lshl_add_u32 v3, v2, 9, v3
    v_add_u32 v3, s58, v3
    v_xor_b32 v4, 8, v1
    v_lshlrev_b32 v4, 4, v4
    v_add_u32 v4, s59, v4
    s_mov_b32 s63, 1
    s_lshr_b32 s5, s50, 1
    s_add_u32 s5, s5, 16
    s_mul_i32 s56, s5, 163840
    s_lshl_b32 s5, s54, 10
    s_add_u32 s56, s56, s5
    s_mov_b32 s57, s56
    s_add_u32 s60, s56, 163840
    v_mov_b32 v5, 0xff800000
    v_mov_b32 v6, 0xff800000
M_MAXLOOP:
    buffer_load_dwordx2 v[212:213], v4, s[20:23], s57 offen sc1
    buffer_load_dwordx4 v[208:211], v3, s[20:23], s57 offen sc1
    s_add_u32 s57, s57, 2560
    s_waitcnt vmcnt(0)
    v_mfma_f32_32x32x4_2b_bf16 v[64:95], v[212:213], v[24:25], 0
    s_nop 15
    s_nop 1
    v_mfma_f32_32x32x16_bf16 v[64:79], v[208:211], v[16:19], v[64:79]
    v_mfma_f32_32x32x16_bf16 v[80:95], v[208:211], v[20:23], v[80:95]
    s_nop 11
    v_max3_f32 v5, v5, v64, v65
    v_max3_f32 v5, v5, v66, v67
    v_max3_f32 v5, v5, v68, v69
    v_max3_f32 v5, v5, v70, v71
    v_max3_f32 v5, v5, v72, v73
    v_max3_f32 v5, v5, v74, v75
    v_max3_f32 v5, v5, v76, v77
    v_max3_f32 v5, v5, v78, v79
    v_max3_f32 v6, v6, v80, v81
    v_max3_f32 v6, v6, v82, v83
    v_max3_f32 v6, v6, v84, v85
    v_max3_f32 v6, v6, v86, v87
    v_max3_f32 v6, v6, v88, v89
    v_max3_f32 v6, v6, v90, v91
    v_max3_f32 v6, v6, v92, v93
    v_max3_f32 v6, v6, v94, v95
    s_cmp_lt_u32 s57, s60
    s_cbranch_scc1 M_MAXLOOP
    v_mov_b32 v7, v5
    v_mov_b32 v31, v6
    s_nop 1
    v_permlane32_swap_b32 v5, v7
    v_permlane32_swap_b32 v6, v31
    v_max_f32 v5, v5, v7
    v_max_f32 v6, v6, v31
    v_pk_mul_f32 v[48:49], v[6:7], -1.0 op_sel_hi:[0,0]
    v_pk_mul_f32 v[32:33], v[4:5], -1.0 op_sel:[1,0] op_sel_hi:[1,0]
    v_pk_mul_f32 v[50:51], v[6:7], -1.0 op_sel_hi:[0,0]
    v_pk_mul_f32 v[34:35], v[4:5], -1.0 op_sel:[1,0] op_sel_hi:[1,0]
    v_pk_mul_f32 v[52:53], v[6:7], -1.0 op_sel_hi:[0,0]
    v_pk_mul_f32 v[36:37], v[4:5], -1.0 op_sel:[1,0] op_sel_hi:[1,0]
    v_pk_mul_f32 v[54:55], v[6:7], -1.0 op_sel_hi:[0,0]
    v_pk_mul_f32 v[38:39], v[4:5], -1.0 op_sel:[1,0] op_sel_hi:[1,0]
    v_pk_mul_f32 v[56:57], v[6:7], -1.0 op_sel_hi:[0,0]
    v_pk_mul_f32 v[40:41], v[4:5], -1.0 op_sel:[1,0] op_sel_hi:[1,0]
    v_pk_mul_f32 v[58:59], v[6:7], -1.0 op_sel_hi:[0,0]
    v_pk_mul_f32 v[42:43], v[4:5], -1.0 op_sel:[1,0] op_sel_hi:[1,0]
    v_pk_mul_f32 v[60:61], v[6:7], -1.0 op_sel_hi:[0,0]
    v_pk_mul_f32 v[44:45], v[4:5], -1.0 op_sel:[1,0] op_sel_hi:[1,0]
    v_pk_mul_f32 v[62:63], v[6:7], -1.0 op_sel_hi:[0,0]
    v_pk_mul_f32 v[46:47], v[4:5], -1.0 op_sel:[1,0] op_sel_hi:[1,0]
    v_mov_b32 v160, 0
    v_mov_b32 v161, 0
    v_mov_b32 v162, 0
    v_mov_b32 v163, 0
    v_mov_b32 v164, 0
    v_mov_b32 v165, 0
    v_mov_b32 v166, 0
    v_mov_b32 v167, 0
    v_mov_b32 v168, 0
    v_mov_b32 v169, 0
    v_mov_b32 v170, 0
    v_mov_b32 v171, 0
    v_mov_b32 v172, 0
    v_mov_b32 v173, 0
    v_mov_b32 v174, 0
    v_mov_b32 v175, 0
    v_mov_b32 v176, 0
    v_mov_b32 v177, 0
    v_mov_b32 v178, 0
    v_mov_b32 v179, 0
    v_mov_b32 v180, 0
    v_mov_b32 v181, 0
    v_mov_b32 v182, 0
    v_mov_b32 v183, 0
    v_mov_b32 v184, 0
    v_mov_b32 v185, 0
    v_mov_b32 v186, 0
    v_mov_b32 v187, 0
    v_mov_b32 v188, 0
    v_mov_b32 v189, 0
    v_mov_b32 v190, 0
    v_mov_b32 v191, 0
    v_mov_b32 v216, 0x3f803f80
    v_mov_b32 v217, 0x3f803f80
    v_mov_b32 v218, 0x3f803f80
    v_mov_b32 v219, 0x3f803f80
    v_mov_b32 v220, 0x3f803f80
    v_mov_b32 v221, 0x3f803f80
    v_mov_b32 v222, 0x3f803f80
    v_mov_b32 v223, 0x3f803f80
    v_mul_u32_u24 v5, 320, v2
    v_lshl_add_u32 v5, v1, 4, v5
    s_mul_i32 s61, s50, 81920
    s_add_u32 s61, s61, 6291456
M_REDOLOOP:
    buffer_load_dwordx2 v[212:213], v4, s[20:23], s56 offen sc1
    buffer_load_dwordx4 v[208:211], v3, s[20:23], s56 offen sc1
    s_mov_b32 exec_lo, 0xfffff
    s_mov_b32 exec_hi, 0xfffff
    buffer_load_dwordx4 v[216:219], v5, s[20:23], s61 offen sc1
    buffer_load_dwordx4 v[220:223], v5, s[20:23], s61 offen offset:640 sc1
    s_mov_b64 exec, -1
    s_add_u32 s56, s56, 2560
    s_add_u32 s61, s61, 1280
    s_waitcnt vmcnt(0)
    v_mfma_f32_32x32x4_2b_bf16 v[64:95], v[212:213], v[24:25], v[32:63]
    s_nop 15
    s_nop 1
    v_mfma_f32_32x32x16_bf16 v[64:79], v[208:211], v[16:19], v[64:79]
    v_mfma_f32_32x32x16_bf16 v[80:95], v[208:211], v[20:23], v[80:95]
    s_nop 11
    v_exp_f32 v64, v64
    v_exp_f32 v65, v65
    v_exp_f32 v66, v66
    v_exp_f32 v67, v67
    v_exp_f32 v68, v68
    v_exp_f32 v69, v69
    v_exp_f32 v70, v70
    v_exp_f32 v71, v71
    v_exp_f32 v72, v72
    v_exp_f32 v73, v73
    v_exp_f32 v74, v74
    v_exp_f32 v75, v75
    v_exp_f32 v76, v76
    v_exp_f32 v77, v77
    v_exp_f32 v78, v78
    v_exp_f32 v79, v79
    v_exp_f32 v80, v80
    v_exp_f32 v81, v81
    v_exp_f32 v82, v82
    v_exp_f32 v83, v83
    v_exp_f32 v84, v84
    v_exp_f32 v85, v85
    v_exp_f32 v86, v86
    v_exp_f32 v87, v87
    v_exp_f32 v88, v88
    v_exp_f32 v89, v89
    v_exp_f32 v90, v90
    v_exp_f32 v91, v91
    v_exp_f32 v92, v92
    v_exp_f32 v93, v93
    v_exp_f32 v94, v94
    v_exp_f32 v95, v95
    v_cvt_pk_bf16_f32 v232, v64, v65
    v_cvt_pk_bf16_f32 v233, v66, v67
    v_cvt_pk_bf16_f32 v234, v68, v69
    v_cvt_pk_bf16_f32 v235, v70, v71
    v_cvt_pk_bf16_f32 v236, v72, v73
    v_cvt_pk_bf16_f32 v237, v74, v75
    v_cvt_pk_bf16_f32 v238, v76, v77
    v_cvt_pk_bf16_f32 v239, v78, v79
    v_cvt_pk_bf16_f32 v240, v80, v81
    v_cvt_pk_bf16_f32 v241, v82, v83
    v_cvt_pk_bf16_f32 v242, v84, v85
    v_cvt_pk_bf16_f32 v243, v86, v87
    v_cvt_pk_bf16_f32 v244, v88, v89
    v_cvt_pk_bf16_f32 v245, v90, v91
    v_cvt_pk_bf16_f32 v246, v92, v93
    v_cvt_pk_bf16_f32 v247, v94, v95
    s_nop 1
    v_mfma_f32_32x32x16_bf16 v[160:175], v[216:219], v[232:235], v[160:175]
    v_mfma_f32_32x32x16_bf16 v[160:175], v[220:223], v[236:239], v[160:175]
    v_mfma_f32_32x32x16_bf16 v[176:191], v[216:219], v[240:243], v[176:191]
    v_mfma_f32_32x32x16_bf16 v[176:191], v[220:223], v[244:247], v[176:191]
    s_cmp_lt_u32 s56, s60
    s_cbranch_scc1 M_REDOLOOP
    s_branch M_EPI
L_END:
L_EXIT:
    s_endpgm
.section .rodata,"a"
.p2align 6
.amdhsa_kernel gated_mix__mha_block__dense_activation_mish__prompt_kernel
  .amdhsa_next_free_vgpr 256
  .amdhsa_next_free_sgpr 102
  .amdhsa_accum_offset 256
  .amdhsa_group_segment_fixed_size 0
  .amdhsa_kernarg_size 88
  .amdhsa_user_sgpr_count 2
  .amdhsa_user_sgpr_kernarg_segment_ptr 1
  .amdhsa_system_sgpr_workgroup_id_x 1
  .amdhsa_float_denorm_mode_32 3
  .amdhsa_ieee_mode 0
.end_amdhsa_kernel
```
